```python
import torch

def _softmax(x, axis=-1):
    return torch.softmax(x, dim=axis)
def _gelu(x):
    return torch.nn.functional.gelu(x, approximate="tanh")
def _silu(x):
    return torch.nn.functional.silu(x)
def _sigmoid(x):
    return torch.sigmoid(x)
def _layernorm(x, axis=-1, eps=1e-5):
    m = x.mean(dim=axis, keepdim=True)
    v = x.var(dim=axis, keepdim=True, unbiased=False)
    return (x - m) / torch.sqrt(v + eps)
def _scatter_add(tgt, idx, src, axis=0):
    return tgt.clone().index_add_(axis, idx, src)
def _segment_sum(src, seg, n):
    out = torch.zeros((n,) + src.shape[1:], dtype=src.dtype)
    return out.index_add_(0, seg, src)
def _pad(x, pw):
    flat = tuple(v for pair in reversed(pw) for v in pair)
    return torch.nn.functional.pad(x, flat)

kernel_name = 'standalone__gqa_block_cached__near_ridge'

def setup_inputs():

    _w = (lambda a: (lambda t: t.to(torch.bfloat16) if t.is_floating_point() else t)(torch.as_tensor(a)))
    B, Sq, D = 16, 48, 512
    Hq, Hkv, Sk, Dh = 32, 8, 512, 128
    assert Hq % Hkv == 0, (Hq, Hkv)
    return {
        "x": _w((lambda *s: torch.randn(*s, dtype=torch.bfloat16) * 0.8)(B, Sq, D)),
        "k_cache": _w((lambda *s: torch.randn(*s, dtype=torch.bfloat16) * 0.8)(B, Hkv, Sk, Dh)),
        "v_cache": _w((lambda *s: torch.randn(*s, dtype=torch.bfloat16) * 0.05)(B, Hkv, Sk, Dh)),
        "wq": _w((lambda *s: torch.randn(*s, dtype=torch.bfloat16) * 0.8)(D, Hq * Dh) * (D ** -0.5)),
        "wo": _w((lambda *s: torch.randn(*s, dtype=torch.bfloat16) * 0.05)(Hq * Dh, D) * ((Hq * Dh) ** -0.5)),
    }

def reference(x, k_cache, v_cache, wq, wo):
    B, Sq, D = x.shape
    Hq, Dh = 32, 128
    Hkv = k_cache.shape[1]
    rep = Hq // Hkv
    q = (lambda x, *d: x.permute(*d))((x @ wq).reshape(B, Sq, Hq, Dh), 0, 2, 1, 3)
    k = (lambda x, n, axis: torch.repeat_interleave(x, n, dim=axis))(k_cache, rep, axis=1)
    v = (lambda x, n, axis: torch.repeat_interleave(x, n, dim=axis))(v_cache, rep, axis=1)
    scores = torch.einsum("bhqd,bhkd->bhqk", q, k) * (Dh ** -0.5)
    p = _softmax(scores, axis=-1)
    o = torch.einsum("bhqk,bhkd->bhqd", p, v)
    return (lambda x, *d: x.permute(*d))(o, 0, 2, 1, 3).reshape(B, Sq, Hq * Dh) @ wo
```

```asm
; @launch kernel=gqa_attn_kernel grid=(256,1,1) block=(256,1,1) lds=163840
; @launch kernel=gqa_oproj_kernel grid=(256,1,1) block=(384,1,1) lds=0
.amdgcn_target "amdgcn-amd-amdhsa--gfx950"
.text
.p2align 8
.globl gqa_attn_kernel
.type gqa_attn_kernel,@function
gqa_attn_kernel:
  s_cmp_ge_u32 s2, 256
  s_cbranch_scc1 L_a_done
  s_load_dwordx16 s[40:55], s[0:1], 0
  v_and_b32 v1, 63, v0
  v_lshrrev_b32 v2, 6, v0
  s_nop 0
  v_readfirstlane_b32 s3, v2
  s_getpc_b64 s[68:69]
L_pc:
  s_and_b32 s69, s69, 0xffff
  s_mov_b32 s70, L_text_end-L_pc
  s_mov_b32 s71, 0x20000
  v_lshlrev_b32 v255, 7, v0
  buffer_load_dword v255, v255, s[68:71], 0 offen
  s_and_b32 s38, s2, 7
  s_lshr_b32 s4, s2, 3
  s_lshr_b32 s37, s4, 1
  s_and_b32 s4, s4, 1
  s_lshl_b32 s39, s38, 2
  s_lshl_b32 s4, s4, 1
  s_add_u32 s39, s39, s4
  s_lshl_b32 s4, s37, 3
  s_add_u32 s4, s4, s38
  s_lshl_b32 s32, s4, 17
  s_lshl_b32 s5, s3, 15
  s_add_u32 s32, s32, s5
  s_lshr_b32 s5, s2, 3
  s_and_b32 s5, s5, 1
  s_mul_i32 s5, s5, 0
  s_add_u32 s6, s5, 0
  s_and_b32 s6, s6, 3
  s_lshl_b32 s6, s6, 13
  s_add_u32 s64, s32, s6
  s_add_u32 s6, s5, 1
  s_and_b32 s6, s6, 3
  s_lshl_b32 s6, s6, 13
  s_add_u32 s65, s32, s6
  s_add_u32 s6, s5, 2
  s_and_b32 s6, s6, 3
  s_lshl_b32 s6, s6, 13
  s_add_u32 s66, s32, s6
  s_add_u32 s6, s5, 3
  s_and_b32 s6, s6, 3
  s_lshl_b32 s6, s6, 13
  s_add_u32 s67, s32, s6
  s_mul_i32 s33, s37, 49152
  s_mul_i32 s5, s3, 12288
  s_add_u32 s33, s33, s5
  s_mul_i32 s35, s3, 12288
  s_add_u32 s35, s35, 98304
  s_mov_b32 s36, 0x3e0293ee
  v_and_b32 v46, 15, v1
  v_lshrrev_b32 v47, 4, v1
  v_xor_b32 v2, v46, v47
  v_lshlrev_b32 v2, 4, v2
  v_lshl_add_u32 v2, v46, 10, v2
  v_lshlrev_b32 v11, 4, v1
  v_lshrrev_b32 v48, 2, v1
  v_and_b32 v48, 3, v48
  v_and_b32 v49, 3, v1
  v_and_b32 v53, 31, v1
  v_lshrrev_b32 v54, 5, v1
  v_lshlrev_b32 v12, 4, v46
  v_lshl_add_u32 v12, v47, 8, v12
  v_lshlrev_b32 v55, 2, v47
  v_xor_b32 v55, v55, v46
  v_lshlrev_b32 v55, 4, v55
  v_lshl_add_u32 v13, v47, 8, v55
  v_lshl_add_u32 v55, v54, 2, v48
  v_lshlrev_b32 v55, 8, v55
  v_xor_b32 v56, s3, v48
  v_lshl_add_u32 v55, v56, 6, v55
  v_and_b32 v56, 1, v47
  v_lshl_add_u32 v55, v56, 5, v55
  v_lshl_add_u32 v14, v49, 3, v55
  v_add_u32 v14, 98304, v14
  s_lshl_b32 s4, s3, 11
  v_add_u32 v15, s4, v11
  v_lshlrev_b32 v20, 5, v53
  v_lshl_add_u32 v19, v54, 2, v20
  s_lshl_b32 s4, s3, 3
  v_add_u32 v19, s4, v19
  v_lshlrev_b32 v55, 4, v46
  v_lshl_add_u32 v55, v54, 8, v55
  s_mul_i32 s4, s3, 3072
  s_add_u32 s5, s4, 86016
  s_cmp_eq_u32 s3, 0
  s_cselect_b32 s5, 77824, s5
  s_add_u32 s4, s4, 65536
  s_sub_u32 s5, s5, s4
  v_add_u32 v55, s4, v55
  v_add_u32 v57, 0, v56
  v_cmp_le_u32 vcc, 3, v57
  v_subrev_u32 v58, 3, v57
  v_lshlrev_b32 v58, 10, v58
  v_add_u32 v58, s5, v58
  v_lshlrev_b32 v57, 10, v57
  v_cndmask_b32 v57, v57, v58, vcc
  v_add_u32 v27, v57, v55
  v_add_u32 v57, 2, v56
  v_cmp_le_u32 vcc, 3, v57
  v_subrev_u32 v58, 3, v57
  v_lshlrev_b32 v58, 10, v58
  v_add_u32 v58, s5, v58
  v_lshlrev_b32 v57, 10, v57
  v_cndmask_b32 v57, v57, v58, vcc
  v_add_u32 v28, v57, v55
  v_add_u32 v57, 4, v56
  v_cmp_le_u32 vcc, 3, v57
  v_subrev_u32 v58, 3, v57
  v_lshlrev_b32 v58, 10, v58
  v_add_u32 v58, s5, v58
  v_lshlrev_b32 v57, 10, v57
  v_cndmask_b32 v57, v57, v58, vcc
  v_add_u32 v29, v57, v55
  s_lshr_b32 s72, s3, 1
  s_and_b32 s4, s3, 1
  s_add_u32 s5, s39, s4
  s_lshl_b32 s34, s5, 8
  s_lshl_b32 s5, s72, 21
  s_add_u32 s34, s34, s5
  v_lshlrev_b32 v3, 4, v46
  v_lshl_add_u32 v3, v47, 16, v3
  s_lshl_b32 s5, s72, 9
  v_xor_b32 v2, s5, v2
  v_lshlrev_b32 v55, 4, v46
  v_lshl_add_u32 v55, v47, 11, v55
  s_mul_i32 s4, s4, 3
  s_lshl_b32 s5, s72, 3
  s_add_u32 s5, s5, 24576
  s_add_u32 s6, s4, 0
  s_lshr_b32 s7, s6, 1
  s_lshl_b32 s7, s7, 13
  s_and_b32 s6, s6, 1
  s_lshl_b32 s6, s6, 8
  s_add_u32 s6, s6, s7
  s_add_u32 s6, s6, s5
  v_add_u32 v16, s6, v55
  s_add_u32 s6, s4, 1
  s_lshr_b32 s7, s6, 1
  s_lshl_b32 s7, s7, 13
  s_and_b32 s6, s6, 1
  s_lshl_b32 s6, s6, 8
  s_add_u32 s6, s6, s7
  s_add_u32 s6, s6, s5
  v_add_u32 v17, s6, v55
  s_add_u32 s6, s4, 2
  s_lshr_b32 s7, s6, 1
  s_lshl_b32 s7, s7, 13
  s_and_b32 s6, s6, 1
  s_lshl_b32 s6, s6, 8
  s_add_u32 s6, s6, s7
  s_add_u32 s6, s6, s5
  v_add_u32 v18, s6, v55
  s_xor_b32 s4, s3, 2
  s_mul_i32 s4, s4, 12288
  s_add_u32 s4, s4, 98304
  v_add_u32 v58, s4, v11
  s_mov_b32 s74, 0x05040100
  s_mov_b32 s75, 0x07060302
  s_waitcnt lgkmcnt(0)
  s_mov_b32 s8, s40
  s_and_b32 s9, s41, 0xffff
  s_mov_b32 s10, 0xc0000
  s_mov_b32 s11, 0x20000
  s_mov_b32 s12, s42
  s_and_b32 s13, s43, 0xffff
  s_mov_b32 s14, 0x1000000
  s_mov_b32 s15, 0x20000
  s_mov_b32 s16, s44
  s_and_b32 s17, s45, 0xffff
  s_mov_b32 s18, 0x1000000
  s_mov_b32 s19, 0x20000
  s_mov_b32 s20, s46
  s_and_b32 s21, s47, 0xffff
  s_mov_b32 s22, 0x400000
  s_mov_b32 s23, 0x20000
  s_mov_b32 s24, s48
  s_and_b32 s25, s49, 0xffff
  s_mov_b32 s26, 0x400000
  s_mov_b32 s27, 0x20000
  s_mov_b32 s28, s54
  s_and_b32 s29, s55, 0xffff
  s_mov_b32 s30, 0x3000000
  s_mov_b32 s31, 0x20000
  s_mul_i32 s4, s3, 12288
  s_mul_i32 s5, s3, 12
  s_add_u32 s5, s5, 0
  s_and_b32 s5, s5, 15
  s_lshl_b32 s5, s5, 4
  v_xor_b32 v60, s5, v11
  s_add_u32 s5, s4, 0
  s_mov_b32 m0, s5
  s_add_u32 s6, s33, 0
  buffer_load_dwordx4 v60, s[8:11], s6 offen lds
  s_mul_i32 s5, s3, 12
  s_add_u32 s5, s5, 1
  s_and_b32 s5, s5, 15
  s_lshl_b32 s5, s5, 4
  v_xor_b32 v61, s5, v11
  s_add_u32 s5, s4, 1024
  s_mov_b32 m0, s5
  s_add_u32 s6, s33, 1024
  buffer_load_dwordx4 v61, s[8:11], s6 offen lds
  s_mul_i32 s5, s3, 12
  s_add_u32 s5, s5, 2
  s_and_b32 s5, s5, 15
  s_lshl_b32 s5, s5, 4
  v_xor_b32 v60, s5, v11
  s_add_u32 s5, s4, 2048
  s_mov_b32 m0, s5
  s_add_u32 s6, s33, 2048
  buffer_load_dwordx4 v60, s[8:11], s6 offen lds
  s_mul_i32 s5, s3, 12
  s_add_u32 s5, s5, 3
  s_and_b32 s5, s5, 15
  s_lshl_b32 s5, s5, 4
  v_xor_b32 v61, s5, v11
  s_add_u32 s5, s4, 3072
  s_mov_b32 m0, s5
  s_add_u32 s6, s33, 3072
  buffer_load_dwordx4 v61, s[8:11], s6 offen lds
  s_mul_i32 s5, s3, 12
  s_add_u32 s5, s5, 4
  s_and_b32 s5, s5, 15
  s_lshl_b32 s5, s5, 4
  v_xor_b32 v60, s5, v11
  s_add_u32 s5, s4, 4096
  s_mov_b32 m0, s5
  s_add_u32 s6, s33, 4096
  buffer_load_dwordx4 v60, s[8:11], s6 offen lds
  s_mul_i32 s5, s3, 12
  s_add_u32 s5, s5, 5
  s_and_b32 s5, s5, 15
  s_lshl_b32 s5, s5, 4
  v_xor_b32 v61, s5, v11
  s_add_u32 s5, s4, 5120
  s_mov_b32 m0, s5
  s_add_u32 s6, s33, 5120
  buffer_load_dwordx4 v61, s[8:11], s6 offen lds
  s_mul_i32 s5, s3, 12
  s_add_u32 s5, s5, 6
  s_and_b32 s5, s5, 15
  s_lshl_b32 s5, s5, 4
  v_xor_b32 v60, s5, v11
  s_add_u32 s5, s4, 6144
  s_mov_b32 m0, s5
  s_add_u32 s6, s33, 6144
  buffer_load_dwordx4 v60, s[8:11], s6 offen lds
  s_mul_i32 s5, s3, 12
  s_add_u32 s5, s5, 7
  s_and_b32 s5, s5, 15
  s_lshl_b32 s5, s5, 4
  v_xor_b32 v61, s5, v11
  s_add_u32 s5, s4, 7168
  s_mov_b32 m0, s5
  s_add_u32 s6, s33, 7168
  buffer_load_dwordx4 v61, s[8:11], s6 offen lds
  s_mul_i32 s5, s3, 12
  s_add_u32 s5, s5, 8
  s_and_b32 s5, s5, 15
  s_lshl_b32 s5, s5, 4
  v_xor_b32 v60, s5, v11
  s_add_u32 s5, s4, 8192
  s_mov_b32 m0, s5
  s_add_u32 s6, s33, 8192
  buffer_load_dwordx4 v60, s[8:11], s6 offen lds
  s_mul_i32 s5, s3, 12
  s_add_u32 s5, s5, 9
  s_and_b32 s5, s5, 15
  s_lshl_b32 s5, s5, 4
  v_xor_b32 v61, s5, v11
  s_add_u32 s5, s4, 9216
  s_mov_b32 m0, s5
  s_add_u32 s6, s33, 9216
  buffer_load_dwordx4 v61, s[8:11], s6 offen lds
  s_mul_i32 s5, s3, 12
  s_add_u32 s5, s5, 10
  s_and_b32 s5, s5, 15
  s_lshl_b32 s5, s5, 4
  v_xor_b32 v60, s5, v11
  s_add_u32 s5, s4, 10240
  s_mov_b32 m0, s5
  s_add_u32 s6, s33, 10240
  buffer_load_dwordx4 v60, s[8:11], s6 offen lds
  s_mul_i32 s5, s3, 12
  s_add_u32 s5, s5, 11
  s_and_b32 s5, s5, 15
  s_lshl_b32 s5, s5, 4
  v_xor_b32 v61, s5, v11
  s_add_u32 s5, s4, 11264
  s_mov_b32 m0, s5
  s_add_u32 s6, s33, 11264
  buffer_load_dwordx4 v61, s[8:11], s6 offen lds
  v_add_u32 v59, s35, v11
  s_add_u32 s6, s34, 0
  buffer_load_dwordx4 v[96:99], v3, s[20:23], s6 offen
  s_add_u32 s6, s34, 8192
  buffer_load_dwordx4 v[100:103], v3, s[20:23], s6 offen
  s_add_u32 s6, s34, 16384
  buffer_load_dwordx4 v[104:107], v3, s[20:23], s6 offen
  s_add_u32 s6, s34, 24576
  buffer_load_dwordx4 v[108:111], v3, s[20:23], s6 offen
  s_add_u32 s6, s34, 32768
  buffer_load_dwordx4 v[112:115], v3, s[20:23], s6 offen
  s_add_u32 s6, s34, 40960
  buffer_load_dwordx4 v[116:119], v3, s[20:23], s6 offen
  s_add_u32 s6, s34, 49152
  buffer_load_dwordx4 v[120:123], v3, s[20:23], s6 offen
  s_add_u32 s6, s34, 57344
  buffer_load_dwordx4 v[124:127], v3, s[20:23], s6 offen
  s_add_u32 s6, s34, 262144
  buffer_load_dwordx4 v[128:131], v3, s[20:23], s6 offen
  s_add_u32 s6, s34, 270336
  buffer_load_dwordx4 v[132:135], v3, s[20:23], s6 offen
  s_add_u32 s6, s34, 278528
  buffer_load_dwordx4 v[136:139], v3, s[20:23], s6 offen
  s_add_u32 s6, s34, 286720
  buffer_load_dwordx4 v[140:143], v3, s[20:23], s6 offen
  s_lshr_b32 s4, s2, 3
  s_lshl_b32 s4, s4, 2
  s_add_u32 s4, s4, s3
  s_lshl_b32 s4, s4, 15
  s_lshr_b32 s5, s38, 0
  s_lshl_b32 s5, s5, 10
  s_add_u32 s4, s4, s5
  v_lshrrev_b32 v62, 4, v1
  v_lshlrev_b32 v62, 13, v62
  v_and_b32 v63, 15, v1
  v_lshl_add_u32 v62, v63, 6, v62
  buffer_load_dword v62, v62, s[20:23], s4 offen
  s_add_u32 s6, s34, 294912
  buffer_load_dwordx4 v[144:147], v3, s[20:23], s6 offen
  s_add_u32 s6, s34, 303104
  buffer_load_dwordx4 v[148:151], v3, s[20:23], s6 offen
  s_add_u32 s6, s34, 311296
  buffer_load_dwordx4 v[152:155], v3, s[20:23], s6 offen
  s_add_u32 s6, s34, 319488
  buffer_load_dwordx4 v[156:159], v3, s[20:23], s6 offen
  s_add_u32 s6, s34, 524288
  buffer_load_dwordx4 v[160:163], v3, s[20:23], s6 offen
  s_add_u32 s6, s34, 532480
  buffer_load_dwordx4 v[164:167], v3, s[20:23], s6 offen
  s_add_u32 s6, s34, 540672
  buffer_load_dwordx4 v[168:171], v3, s[20:23], s6 offen
  s_add_u32 s6, s34, 548864
  buffer_load_dwordx4 v[172:175], v3, s[20:23], s6 offen
  s_add_u32 s6, s34, 557056
  buffer_load_dwordx4 v[176:179], v3, s[20:23], s6 offen
  s_add_u32 s6, s34, 565248
  buffer_load_dwordx4 v[180:183], v3, s[20:23], s6 offen
  s_add_u32 s6, s34, 573440
  buffer_load_dwordx4 v[184:187], v3, s[20:23], s6 offen
  s_add_u32 s6, s34, 581632
  buffer_load_dwordx4 v[188:191], v3, s[20:23], s6 offen
  s_lshl_b32 s4, s3, 13
  s_add_u32 s4, s4, 0xC000
  v_and_b32 v46, 15, v1
  v_lshrrev_b32 v47, 4, v1
  v_xor_b32 v48, v46, v47
  s_mov_b32 s76, s4
  s_lshl_b32 s5, s3, 13
  s_sub_u32 s77, s64, s5
  s_sub_u32 s78, s66, s5
  s_sub_u32 s79, s67, s5
  s_sub_u32 s81, s65, s5
  v_xor_b32 v49, 0, v48
  v_lshlrev_b32 v49, 4, v49
  v_lshl_add_u32 v49, v47, 8, v49
  v_add_u32 v6, s5, v49
  v_xor_b32 v49, 4, v48
  v_lshlrev_b32 v49, 4, v49
  v_lshl_add_u32 v49, v47, 8, v49
  v_add_u32 v7, s5, v49
  v_xor_b32 v49, 8, v48
  v_lshlrev_b32 v49, 4, v49
  v_lshl_add_u32 v49, v47, 8, v49
  v_add_u32 v8, s5, v49
  v_xor_b32 v49, 12, v48
  v_lshlrev_b32 v49, 4, v49
  v_lshl_add_u32 v49, v47, 8, v49
  v_add_u32 v9, s5, v49
  v_and_b32 v46, 31, v1
  v_lshrrev_b32 v47, 5, v1
  v_and_b32 v48, 15, v1
  v_xor_b32 v48, v48, v47
  v_lshlrev_b32 v48, 4, v48
  v_lshl_add_u32 v48, v46, 8, v48
  v_add_u32 v54, s4, v48
  s_waitcnt vmcnt(25)
  s_barrier
  v_xor_b32 v60, 0, v2
  ds_read_b128 a[224:227], v60 offset:0
  ds_read_b128 a[228:231], v60 offset:16384
  ds_read_b128 a[232:235], v60 offset:32768
  s_waitcnt vmcnt(17)
  v_perm_b32 v64, v100, v96, s74
  v_perm_b32 v68, v100, v96, s75
  v_perm_b32 v65, v108, v104, s74
  v_perm_b32 v69, v108, v104, s75
  v_perm_b32 v66, v116, v112, s74
  v_perm_b32 v70, v116, v112, s75
  v_perm_b32 v67, v124, v120, s74
  v_perm_b32 v71, v124, v120, s75
  v_perm_b32 v72, v101, v97, s74
  v_perm_b32 v76, v101, v97, s75
  v_perm_b32 v73, v109, v105, s74
  v_perm_b32 v77, v109, v105, s75
  v_perm_b32 v74, v117, v113, s74
  v_perm_b32 v78, v117, v113, s75
  v_perm_b32 v75, v125, v121, s74
  v_perm_b32 v79, v125, v121, s75
  s_waitcnt lgkmcnt(0)
  v_mfma_f32_16x16x32_bf16 a[128:131], v[64:67], a[224:227], 0
  v_perm_b32 v80, v102, v98, s74
  v_perm_b32 v84, v102, v98, s75
  v_mfma_f32_16x16x32_bf16 a[132:135], v[64:67], a[228:231], 0
  s_add_u32 s6, s34, 786432
  buffer_load_dwordx4 v[192:195], v3, s[20:23], s6 offen
  v_mfma_f32_16x16x32_bf16 a[136:139], v[64:67], a[232:235], 0
  v_perm_b32 v81, v110, v106, s74
  v_perm_b32 v85, v110, v106, s75
  v_mfma_f32_16x16x32_bf16 a[140:143], v[68:71], a[224:227], 0
  v_perm_b32 v82, v118, v114, s74
  v_perm_b32 v86, v118, v114, s75
  v_mfma_f32_16x16x32_bf16 a[144:147], v[68:71], a[228:231], 0
  s_add_u32 s6, s34, 794624
  buffer_load_dwordx4 v[196:199], v3, s[20:23], s6 offen
  v_mfma_f32_16x16x32_bf16 a[148:151], v[68:71], a[232:235], 0
  v_perm_b32 v83, v126, v122, s74
  v_perm_b32 v87, v126, v122, s75
  v_mfma_f32_16x16x32_bf16 a[152:155], v[72:75], a[224:227], 0
  v_perm_b32 v88, v103, v99, s74
  v_perm_b32 v92, v103, v99, s75
  s_add_u32 s6, s34, 802816
  buffer_load_dwordx4 v[200:203], v3, s[20:23], s6 offen
  v_mfma_f32_16x16x32_bf16 a[156:159], v[72:75], a[228:231], 0
  v_xor_b32 v61, 64, v2
  v_perm_b32 v89, v111, v107, s74
  v_perm_b32 v93, v111, v107, s75
  v_mfma_f32_16x16x32_bf16 a[160:163], v[72:75], a[232:235], 0
  ds_read_b128 a[236:239], v61 offset:0
  s_add_u32 s6, s34, 811008
  buffer_load_dwordx4 v[204:207], v3, s[20:23], s6 offen
  v_mfma_f32_16x16x32_bf16 a[164:167], v[76:79], a[224:227], 0
  v_perm_b32 v90, v119, v115, s74
  v_perm_b32 v94, v119, v115, s75
  v_mfma_f32_16x16x32_bf16 a[168:171], v[76:79], a[228:231], 0
  ds_read_b128 a[240:243], v61 offset:16384
  s_add_u32 s6, s34, 819200
  buffer_load_dwordx4 v[208:211], v3, s[20:23], s6 offen
  v_mfma_f32_16x16x32_bf16 a[172:175], v[76:79], a[232:235], 0
  v_perm_b32 v91, v127, v123, s74
  v_perm_b32 v95, v127, v123, s75
  ds_read_b128 a[244:247], v61 offset:32768
  v_mfma_f32_16x16x32_bf16 a[176:179], v[80:83], a[224:227], 0
  s_add_u32 s6, s34, 827392
  buffer_load_dwordx4 v[212:215], v3, s[20:23], s6 offen
  v_mfma_f32_16x16x32_bf16 a[180:183], v[80:83], a[228:231], 0
  v_mfma_f32_16x16x32_bf16 a[184:187], v[80:83], a[232:235], 0
  s_add_u32 s6, s34, 835584
  buffer_load_dwordx4 v[216:219], v3, s[20:23], s6 offen
  v_mfma_f32_16x16x32_bf16 a[188:191], v[84:87], a[224:227], 0
  s_waitcnt vmcnt(15)
  v_perm_b32 v64, v132, v128, s74
  v_perm_b32 v68, v132, v128, s75
  v_mfma_f32_16x16x32_bf16 a[192:195], v[84:87], a[228:231], 0
  v_perm_b32 v65, v140, v136, s74
  v_perm_b32 v69, v140, v136, s75
  v_perm_b32 v66, v148, v144, s74
  v_perm_b32 v70, v148, v144, s75
  v_mfma_f32_16x16x32_bf16 a[196:199], v[84:87], a[232:235], 0
  v_perm_b32 v67, v156, v152, s74
  v_perm_b32 v71, v156, v152, s75
  v_mfma_f32_16x16x32_bf16 a[200:203], v[88:91], a[224:227], 0
  v_perm_b32 v72, v133, v129, s74
  v_perm_b32 v76, v133, v129, s75
  v_mfma_f32_16x16x32_bf16 a[204:207], v[88:91], a[228:231], 0
  s_add_u32 s6, s34, 843776
  buffer_load_dwordx4 v[220:223], v3, s[20:23], s6 offen
  v_mfma_f32_16x16x32_bf16 a[208:211], v[88:91], a[232:235], 0
  v_perm_b32 v73, v141, v137, s74
  v_perm_b32 v77, v141, v137, s75
  s_add_u32 s6, s34, 1048576
  buffer_load_dwordx4 v[224:227], v3, s[20:23], s6 offen
  v_mfma_f32_16x16x32_bf16 a[212:215], v[92:95], a[224:227], 0
  v_perm_b32 v74, v149, v145, s74
  v_perm_b32 v78, v149, v145, s75
  v_mfma_f32_16x16x32_bf16 a[216:219], v[92:95], a[228:231], 0
  s_add_u32 s6, s34, 1056768
  buffer_load_dwordx4 v[228:231], v3, s[20:23], s6 offen
  v_mfma_f32_16x16x32_bf16 a[220:223], v[92:95], a[232:235], 0
  v_perm_b32 v75, v157, v153, s74
  v_perm_b32 v79, v157, v153, s75
  s_waitcnt lgkmcnt(0)
  v_mfma_f32_16x16x32_bf16 a[128:131], v[64:67], a[236:239], a[128:131]
  v_perm_b32 v80, v134, v130, s74
  v_perm_b32 v84, v134, v130, s75
  v_mfma_f32_16x16x32_bf16 a[132:135], v[64:67], a[240:243], a[132:135]
  s_add_u32 s6, s34, 1064960
  buffer_load_dwordx4 v[232:235], v3, s[20:23], s6 offen
  v_mfma_f32_16x16x32_bf16 a[136:139], v[64:67], a[244:247], a[136:139]
  v_perm_b32 v81, v142, v138, s74
  v_perm_b32 v85, v142, v138, s75
  v_mfma_f32_16x16x32_bf16 a[140:143], v[68:71], a[236:239], a[140:143]
  v_perm_b32 v82, v150, v146, s74
  v_perm_b32 v86, v150, v146, s75
  v_mfma_f32_16x16x32_bf16 a[144:147], v[68:71], a[240:243], a[144:147]
  s_add_u32 s6, s34, 1073152
  buffer_load_dwordx4 v[236:239], v3, s[20:23], s6 offen
  v_mfma_f32_16x16x32_bf16 a[148:151], v[68:71], a[244:247], a[148:151]
  v_perm_b32 v83, v158, v154, s74
  v_perm_b32 v87, v158, v154, s75
  v_mfma_f32_16x16x32_bf16 a[152:155], v[72:75], a[236:239], a[152:155]
  v_perm_b32 v88, v135, v131, s74
  v_perm_b32 v92, v135, v131, s75
  s_add_u32 s6, s34, 1081344
  buffer_load_dwordx4 v[240:243], v3, s[20:23], s6 offen
  v_mfma_f32_16x16x32_bf16 a[156:159], v[72:75], a[240:243], a[156:159]
  v_xor_b32 v60, 128, v2
  v_perm_b32 v89, v143, v139, s74
  v_perm_b32 v93, v143, v139, s75
  v_mfma_f32_16x16x32_bf16 a[160:163], v[72:75], a[244:247], a[160:163]
  ds_read_b128 a[224:227], v60 offset:0
  s_add_u32 s6, s34, 1089536
  buffer_load_dwordx4 v[244:247], v3, s[20:23], s6 offen
  v_mfma_f32_16x16x32_bf16 a[164:167], v[76:79], a[236:239], a[164:167]
  v_perm_b32 v90, v151, v147, s74
  v_perm_b32 v94, v151, v147, s75
  v_mfma_f32_16x16x32_bf16 a[168:171], v[76:79], a[240:243], a[168:171]
  ds_read_b128 a[228:231], v60 offset:16384
  s_add_u32 s6, s34, 1097728
  buffer_load_dwordx4 v[248:251], v3, s[20:23], s6 offen
  v_mfma_f32_16x16x32_bf16 a[172:175], v[76:79], a[244:247], a[172:175]
  v_perm_b32 v91, v159, v155, s74
  v_perm_b32 v95, v159, v155, s75
  ds_read_b128 a[232:235], v60 offset:32768
  v_mfma_f32_16x16x32_bf16 a[176:179], v[80:83], a[236:239], a[176:179]
  s_add_u32 s6, s34, 1105920
  buffer_load_dwordx4 v[252:255], v3, s[20:23], s6 offen
  v_mfma_f32_16x16x32_bf16 a[180:183], v[80:83], a[240:243], a[180:183]
  v_mfma_f32_16x16x32_bf16 a[184:187], v[80:83], a[244:247], a[184:187]
  s_add_u32 s6, s34, 1310720
  buffer_load_dwordx4 v[96:99], v3, s[20:23], s6 offen
  v_mfma_f32_16x16x32_bf16 a[188:191], v[84:87], a[236:239], a[188:191]
  s_waitcnt vmcnt(17)
  v_perm_b32 v64, v164, v160, s74
  v_perm_b32 v68, v164, v160, s75
  v_mfma_f32_16x16x32_bf16 a[192:195], v[84:87], a[240:243], a[192:195]
  v_perm_b32 v65, v172, v168, s74
  v_perm_b32 v69, v172, v168, s75
  v_perm_b32 v66, v180, v176, s74
  v_perm_b32 v70, v180, v176, s75
  v_mfma_f32_16x16x32_bf16 a[196:199], v[84:87], a[244:247], a[196:199]
  v_perm_b32 v67, v188, v184, s74
  v_perm_b32 v71, v188, v184, s75
  v_mfma_f32_16x16x32_bf16 a[200:203], v[88:91], a[236:239], a[200:203]
  v_perm_b32 v72, v165, v161, s74
  v_perm_b32 v76, v165, v161, s75
  v_mfma_f32_16x16x32_bf16 a[204:207], v[88:91], a[240:243], a[204:207]
  s_add_u32 s6, s34, 1318912
  buffer_load_dwordx4 v[100:103], v3, s[20:23], s6 offen
  v_mfma_f32_16x16x32_bf16 a[208:211], v[88:91], a[244:247], a[208:211]
  v_perm_b32 v73, v173, v169, s74
  v_perm_b32 v77, v173, v169, s75
  s_add_u32 s6, s34, 1327104
  buffer_load_dwordx4 v[104:107], v3, s[20:23], s6 offen
  v_mfma_f32_16x16x32_bf16 a[212:215], v[92:95], a[236:239], a[212:215]
  v_perm_b32 v74, v181, v177, s74
  v_perm_b32 v78, v181, v177, s75
  v_mfma_f32_16x16x32_bf16 a[216:219], v[92:95], a[240:243], a[216:219]
  s_add_u32 s6, s34, 1335296
  buffer_load_dwordx4 v[108:111], v3, s[20:23], s6 offen
  v_mfma_f32_16x16x32_bf16 a[220:223], v[92:95], a[244:247], a[220:223]
  v_perm_b32 v75, v189, v185, s74
  v_perm_b32 v79, v189, v185, s75
  s_waitcnt lgkmcnt(0)
  v_mfma_f32_16x16x32_bf16 a[128:131], v[64:67], a[224:227], a[128:131]
  v_perm_b32 v80, v166, v162, s74
  v_perm_b32 v84, v166, v162, s75
  v_mfma_f32_16x16x32_bf16 a[132:135], v[64:67], a[228:231], a[132:135]
  s_add_u32 s6, s34, 1343488
  buffer_load_dwordx4 v[112:115], v3, s[20:23], s6 offen
  v_mfma_f32_16x16x32_bf16 a[136:139], v[64:67], a[232:235], a[136:139]
  v_perm_b32 v81, v174, v170, s74
  v_perm_b32 v85, v174, v170, s75
  v_mfma_f32_16x16x32_bf16 a[140:143], v[68:71], a[224:227], a[140:143]
  v_perm_b32 v82, v182, v178, s74
  v_perm_b32 v86, v182, v178, s75
  v_mfma_f32_16x16x32_bf16 a[144:147], v[68:71], a[228:231], a[144:147]
  s_add_u32 s6, s34, 1351680
  buffer_load_dwordx4 v[116:119], v3, s[20:23], s6 offen
  v_mfma_f32_16x16x32_bf16 a[148:151], v[68:71], a[232:235], a[148:151]
  v_perm_b32 v83, v190, v186, s74
  v_perm_b32 v87, v190, v186, s75
  v_mfma_f32_16x16x32_bf16 a[152:155], v[72:75], a[224:227], a[152:155]
  v_perm_b32 v88, v167, v163, s74
  v_perm_b32 v92, v167, v163, s75
  s_add_u32 s6, s34, 1359872
  buffer_load_dwordx4 v[120:123], v3, s[20:23], s6 offen
  v_mfma_f32_16x16x32_bf16 a[156:159], v[72:75], a[228:231], a[156:159]
  v_xor_b32 v61, 192, v2
  v_perm_b32 v89, v175, v171, s74
  v_perm_b32 v93, v175, v171, s75
  v_mfma_f32_16x16x32_bf16 a[160:163], v[72:75], a[232:235], a[160:163]
  ds_read_b128 a[236:239], v61 offset:0
  s_add_u32 s6, s34, 1368064
  buffer_load_dwordx4 v[124:127], v3, s[20:23], s6 offen
  v_mfma_f32_16x16x32_bf16 a[164:167], v[76:79], a[224:227], a[164:167]
  v_perm_b32 v90, v183, v179, s74
  v_perm_b32 v94, v183, v179, s75
  v_mfma_f32_16x16x32_bf16 a[168:171], v[76:79], a[228:231], a[168:171]
  ds_read_b128 a[240:243], v61 offset:16384
  s_add_u32 s6, s34, 1572864
  buffer_load_dwordx4 v[128:131], v3, s[20:23], s6 offen
  v_mfma_f32_16x16x32_bf16 a[172:175], v[76:79], a[232:235], a[172:175]
  v_perm_b32 v91, v191, v187, s74
  v_perm_b32 v95, v191, v187, s75
  ds_read_b128 a[244:247], v61 offset:32768
  v_mfma_f32_16x16x32_bf16 a[176:179], v[80:83], a[224:227], a[176:179]
  s_add_u32 s6, s34, 1581056
  buffer_load_dwordx4 v[132:135], v3, s[20:23], s6 offen
  v_mfma_f32_16x16x32_bf16 a[180:183], v[80:83], a[228:231], a[180:183]
  v_mfma_f32_16x16x32_bf16 a[184:187], v[80:83], a[232:235], a[184:187]
  s_add_u32 s6, s34, 1589248
  buffer_load_dwordx4 v[136:139], v3, s[20:23], s6 offen
  v_mfma_f32_16x16x32_bf16 a[188:191], v[84:87], a[224:227], a[188:191]
  s_waitcnt vmcnt(19)
  v_perm_b32 v64, v196, v192, s74
  v_perm_b32 v68, v196, v192, s75
  v_mfma_f32_16x16x32_bf16 a[192:195], v[84:87], a[228:231], a[192:195]
  v_perm_b32 v65, v204, v200, s74
  v_perm_b32 v69, v204, v200, s75
  v_perm_b32 v66, v212, v208, s74
  v_perm_b32 v70, v212, v208, s75
  v_mfma_f32_16x16x32_bf16 a[196:199], v[84:87], a[232:235], a[196:199]
  v_perm_b32 v67, v220, v216, s74
  v_perm_b32 v71, v220, v216, s75
  v_mfma_f32_16x16x32_bf16 a[200:203], v[88:91], a[224:227], a[200:203]
  v_perm_b32 v72, v197, v193, s74
  v_perm_b32 v76, v197, v193, s75
  v_mfma_f32_16x16x32_bf16 a[204:207], v[88:91], a[228:231], a[204:207]
  s_add_u32 s6, s34, 1597440
  buffer_load_dwordx4 v[140:143], v3, s[20:23], s6 offen
  v_mfma_f32_16x16x32_bf16 a[208:211], v[88:91], a[232:235], a[208:211]
  v_perm_b32 v73, v205, v201, s74
  v_perm_b32 v77, v205, v201, s75
  s_add_u32 s6, s34, 1605632
  buffer_load_dwordx4 v[144:147], v3, s[20:23], s6 offen
  v_mfma_f32_16x16x32_bf16 a[212:215], v[92:95], a[224:227], a[212:215]
  v_perm_b32 v74, v213, v209, s74
  v_perm_b32 v78, v213, v209, s75
  v_mfma_f32_16x16x32_bf16 a[216:219], v[92:95], a[228:231], a[216:219]
  s_add_u32 s6, s34, 1613824
  buffer_load_dwordx4 v[148:151], v3, s[20:23], s6 offen
  v_mfma_f32_16x16x32_bf16 a[220:223], v[92:95], a[232:235], a[220:223]
  v_perm_b32 v75, v221, v217, s74
  v_perm_b32 v79, v221, v217, s75
  s_waitcnt lgkmcnt(0)
  v_mfma_f32_16x16x32_bf16 a[128:131], v[64:67], a[236:239], a[128:131]
  v_perm_b32 v80, v198, v194, s74
  v_perm_b32 v84, v198, v194, s75
  v_mfma_f32_16x16x32_bf16 a[132:135], v[64:67], a[240:243], a[132:135]
  s_add_u32 s6, s34, 1622016
  buffer_load_dwordx4 v[152:155], v3, s[20:23], s6 offen
  v_mfma_f32_16x16x32_bf16 a[136:139], v[64:67], a[244:247], a[136:139]
  v_perm_b32 v81, v206, v202, s74
  v_perm_b32 v85, v206, v202, s75
  v_mfma_f32_16x16x32_bf16 a[140:143], v[68:71], a[236:239], a[140:143]
  v_perm_b32 v82, v214, v210, s74
  v_perm_b32 v86, v214, v210, s75
  v_mfma_f32_16x16x32_bf16 a[144:147], v[68:71], a[240:243], a[144:147]
  s_add_u32 s6, s34, 1630208
  buffer_load_dwordx4 v[156:159], v3, s[20:23], s6 offen
  v_mfma_f32_16x16x32_bf16 a[148:151], v[68:71], a[244:247], a[148:151]
  v_perm_b32 v83, v222, v218, s74
  v_perm_b32 v87, v222, v218, s75
  v_mfma_f32_16x16x32_bf16 a[152:155], v[72:75], a[236:239], a[152:155]
  v_perm_b32 v88, v199, v195, s74
  v_perm_b32 v92, v199, v195, s75
  s_add_u32 s6, s34, 1835008
  buffer_load_dwordx4 v[160:163], v3, s[20:23], s6 offen
  v_mfma_f32_16x16x32_bf16 a[156:159], v[72:75], a[240:243], a[156:159]
  v_xor_b32 v60, 256, v2
  v_perm_b32 v89, v207, v203, s74
  v_perm_b32 v93, v207, v203, s75
  v_mfma_f32_16x16x32_bf16 a[160:163], v[72:75], a[244:247], a[160:163]
  ds_read_b128 a[224:227], v60 offset:0
  s_add_u32 s6, s34, 1843200
  buffer_load_dwordx4 v[164:167], v3, s[20:23], s6 offen
  v_mfma_f32_16x16x32_bf16 a[164:167], v[76:79], a[236:239], a[164:167]
  v_perm_b32 v90, v215, v211, s74
  v_perm_b32 v94, v215, v211, s75
  v_mfma_f32_16x16x32_bf16 a[168:171], v[76:79], a[240:243], a[168:171]
  ds_read_b128 a[228:231], v60 offset:16384
  s_add_u32 s6, s34, 1851392
  buffer_load_dwordx4 v[168:171], v3, s[20:23], s6 offen
  v_mfma_f32_16x16x32_bf16 a[172:175], v[76:79], a[244:247], a[172:175]
  v_perm_b32 v91, v223, v219, s74
  v_perm_b32 v95, v223, v219, s75
  ds_read_b128 a[232:235], v60 offset:32768
  v_mfma_f32_16x16x32_bf16 a[176:179], v[80:83], a[236:239], a[176:179]
  s_add_u32 s6, s34, 1859584
  buffer_load_dwordx4 v[172:175], v3, s[20:23], s6 offen
  v_mfma_f32_16x16x32_bf16 a[180:183], v[80:83], a[240:243], a[180:183]
  v_mfma_f32_16x16x32_bf16 a[184:187], v[80:83], a[244:247], a[184:187]
  s_add_u32 s6, s34, 1867776
  buffer_load_dwordx4 v[176:179], v3, s[20:23], s6 offen
  v_mfma_f32_16x16x32_bf16 a[188:191], v[84:87], a[236:239], a[188:191]
  s_waitcnt vmcnt(21)
  v_perm_b32 v64, v228, v224, s74
  v_perm_b32 v68, v228, v224, s75
  v_mfma_f32_16x16x32_bf16 a[192:195], v[84:87], a[240:243], a[192:195]
  v_perm_b32 v65, v236, v232, s74
  v_perm_b32 v69, v236, v232, s75
  v_perm_b32 v66, v244, v240, s74
  v_perm_b32 v70, v244, v240, s75
  v_mfma_f32_16x16x32_bf16 a[196:199], v[84:87], a[244:247], a[196:199]
  v_perm_b32 v67, v252, v248, s74
  v_perm_b32 v71, v252, v248, s75
  v_mfma_f32_16x16x32_bf16 a[200:203], v[88:91], a[236:239], a[200:203]
  v_perm_b32 v72, v229, v225, s74
  v_perm_b32 v76, v229, v225, s75
  v_mfma_f32_16x16x32_bf16 a[204:207], v[88:91], a[240:243], a[204:207]
  s_add_u32 s6, s34, 1875968
  buffer_load_dwordx4 v[180:183], v3, s[20:23], s6 offen
  v_mfma_f32_16x16x32_bf16 a[208:211], v[88:91], a[244:247], a[208:211]
  v_perm_b32 v73, v237, v233, s74
  v_perm_b32 v77, v237, v233, s75
  s_add_u32 s6, s34, 1884160
  buffer_load_dwordx4 v[184:187], v3, s[20:23], s6 offen
  v_mfma_f32_16x16x32_bf16 a[212:215], v[92:95], a[236:239], a[212:215]
  v_perm_b32 v74, v245, v241, s74
  v_perm_b32 v78, v245, v241, s75
  v_mfma_f32_16x16x32_bf16 a[216:219], v[92:95], a[240:243], a[216:219]
  s_add_u32 s6, s34, 1892352
  buffer_load_dwordx4 v[188:191], v3, s[20:23], s6 offen
  v_mfma_f32_16x16x32_bf16 a[220:223], v[92:95], a[244:247], a[220:223]
  v_perm_b32 v75, v253, v249, s74
  v_perm_b32 v79, v253, v249, s75
  s_waitcnt lgkmcnt(0)
  v_mfma_f32_16x16x32_bf16 a[128:131], v[64:67], a[224:227], a[128:131]
  v_perm_b32 v80, v230, v226, s74
  v_perm_b32 v84, v230, v226, s75
  v_mfma_f32_16x16x32_bf16 a[132:135], v[64:67], a[228:231], a[132:135]
  v_mfma_f32_16x16x32_bf16 a[136:139], v[64:67], a[232:235], a[136:139]
  s_add_u32 m0, s76, 0
  s_add_u32 s83, s77, 0
  buffer_load_dwordx4 v6, s[12:15], s83 offen offset:0 lds
  v_mfma_f32_16x16x32_bf16 a[140:143], v[68:71], a[224:227], a[140:143]
  v_perm_b32 v81, v238, v234, s74
  v_perm_b32 v85, v238, v234, s75
  v_mfma_f32_16x16x32_bf16 a[144:147], v[68:71], a[228:231], a[144:147]
  v_perm_b32 v82, v246, v242, s74
  v_perm_b32 v86, v246, v242, s75
  v_mfma_f32_16x16x32_bf16 a[148:151], v[68:71], a[232:235], a[148:151]
  v_perm_b32 v83, v254, v250, s74
  v_perm_b32 v87, v254, v250, s75
  v_mfma_f32_16x16x32_bf16 a[152:155], v[72:75], a[224:227], a[152:155]
  v_perm_b32 v88, v231, v227, s74
  v_perm_b32 v92, v231, v227, s75
  v_mfma_f32_16x16x32_bf16 a[156:159], v[72:75], a[228:231], a[156:159]
  buffer_load_dwordx4 v7, s[12:15], s83 offen offset:1024 lds
  v_mfma_f32_16x16x32_bf16 a[160:163], v[72:75], a[232:235], a[160:163]
  v_xor_b32 v61, 320, v2
  v_mfma_f32_16x16x32_bf16 a[164:167], v[76:79], a[224:227], a[164:167]
  v_perm_b32 v89, v239, v235, s74
  v_perm_b32 v93, v239, v235, s75
  ds_read_b128 a[236:239], v61 offset:0
  v_mfma_f32_16x16x32_bf16 a[168:171], v[76:79], a[228:231], a[168:171]
  v_perm_b32 v90, v247, v243, s74
  v_perm_b32 v94, v247, v243, s75
  ds_read_b128 a[240:243], v61 offset:16384
  v_mfma_f32_16x16x32_bf16 a[172:175], v[76:79], a[232:235], a[172:175]
  v_perm_b32 v91, v255, v251, s74
  v_perm_b32 v95, v255, v251, s75
  ds_read_b128 a[244:247], v61 offset:32768
  v_mfma_f32_16x16x32_bf16 a[176:179], v[80:83], a[224:227], a[176:179]
  v_mfma_f32_16x16x32_bf16 a[180:183], v[80:83], a[228:231], a[180:183]
  buffer_load_dwordx4 v8, s[12:15], s83 offen offset:2048 lds
  v_mfma_f32_16x16x32_bf16 a[184:187], v[80:83], a[232:235], a[184:187]
  s_waitcnt vmcnt(19)
  v_perm_b32 v64, v100, v96, s74
  v_perm_b32 v68, v100, v96, s75
  v_mfma_f32_16x16x32_bf16 a[188:191], v[84:87], a[224:227], a[188:191]
  v_perm_b32 v65, v108, v104, s74
  v_perm_b32 v69, v108, v104, s75
  v_mfma_f32_16x16x32_bf16 a[192:195], v[84:87], a[228:231], a[192:195]
  v_perm_b32 v66, v116, v112, s74
  v_perm_b32 v70, v116, v112, s75
  v_mfma_f32_16x16x32_bf16 a[196:199], v[84:87], a[232:235], a[196:199]
  v_perm_b32 v67, v124, v120, s74
  v_perm_b32 v71, v124, v120, s75
  v_mfma_f32_16x16x32_bf16 a[200:203], v[88:91], a[224:227], a[200:203]
  v_perm_b32 v72, v101, v97, s74
  v_perm_b32 v76, v101, v97, s75
  v_mfma_f32_16x16x32_bf16 a[204:207], v[88:91], a[228:231], a[204:207]
  v_mfma_f32_16x16x32_bf16 a[208:211], v[88:91], a[232:235], a[208:211]
  buffer_load_dwordx4 v9, s[12:15], s83 offen offset:3072 lds
  v_mfma_f32_16x16x32_bf16 a[212:215], v[92:95], a[224:227], a[212:215]
  v_perm_b32 v73, v109, v105, s74
  v_perm_b32 v77, v109, v105, s75
  v_mfma_f32_16x16x32_bf16 a[216:219], v[92:95], a[228:231], a[216:219]
  v_perm_b32 v74, v117, v113, s74
  v_perm_b32 v78, v117, v113, s75
  v_mfma_f32_16x16x32_bf16 a[220:223], v[92:95], a[232:235], a[220:223]
  v_perm_b32 v75, v125, v121, s74
  v_perm_b32 v79, v125, v121, s75
  s_waitcnt lgkmcnt(0)
  v_mfma_f32_16x16x32_bf16 a[128:131], v[64:67], a[236:239], a[128:131]
  v_perm_b32 v80, v102, v98, s74
  v_perm_b32 v84, v102, v98, s75
  v_mfma_f32_16x16x32_bf16 a[132:135], v[64:67], a[240:243], a[132:135]
  v_mfma_f32_16x16x32_bf16 a[136:139], v[64:67], a[244:247], a[136:139]
  s_add_u32 m0, s76, 4096
  s_add_u32 s83, s77, 4096
  buffer_load_dwordx4 v6, s[12:15], s83 offen offset:0 lds
  v_mfma_f32_16x16x32_bf16 a[140:143], v[68:71], a[236:239], a[140:143]
  v_perm_b32 v81, v110, v106, s74
  v_perm_b32 v85, v110, v106, s75
  v_mfma_f32_16x16x32_bf16 a[144:147], v[68:71], a[240:243], a[144:147]
  v_perm_b32 v82, v118, v114, s74
  v_perm_b32 v86, v118, v114, s75
  v_mfma_f32_16x16x32_bf16 a[148:151], v[68:71], a[244:247], a[148:151]
  v_perm_b32 v83, v126, v122, s74
  v_perm_b32 v87, v126, v122, s75
  v_mfma_f32_16x16x32_bf16 a[152:155], v[72:75], a[236:239], a[152:155]
  v_perm_b32 v88, v103, v99, s74
  v_perm_b32 v92, v103, v99, s75
  v_mfma_f32_16x16x32_bf16 a[156:159], v[72:75], a[240:243], a[156:159]
  buffer_load_dwordx4 v7, s[12:15], s83 offen offset:1024 lds
  v_mfma_f32_16x16x32_bf16 a[160:163], v[72:75], a[244:247], a[160:163]
  v_xor_b32 v60, 384, v2
  v_mfma_f32_16x16x32_bf16 a[164:167], v[76:79], a[236:239], a[164:167]
  v_perm_b32 v89, v111, v107, s74
  v_perm_b32 v93, v111, v107, s75
  ds_read_b128 a[224:227], v60 offset:0
  v_mfma_f32_16x16x32_bf16 a[168:171], v[76:79], a[240:243], a[168:171]
  v_perm_b32 v90, v119, v115, s74
  v_perm_b32 v94, v119, v115, s75
  ds_read_b128 a[228:231], v60 offset:16384
  v_mfma_f32_16x16x32_bf16 a[172:175], v[76:79], a[244:247], a[172:175]
  v_perm_b32 v91, v127, v123, s74
  v_perm_b32 v95, v127, v123, s75
  ds_read_b128 a[232:235], v60 offset:32768
  v_mfma_f32_16x16x32_bf16 a[176:179], v[80:83], a[236:239], a[176:179]
  v_mfma_f32_16x16x32_bf16 a[180:183], v[80:83], a[240:243], a[180:183]
  buffer_load_dwordx4 v8, s[12:15], s83 offen offset:2048 lds
  v_mfma_f32_16x16x32_bf16 a[184:187], v[80:83], a[244:247], a[184:187]
  s_waitcnt vmcnt(15)
  v_perm_b32 v64, v132, v128, s74
  v_perm_b32 v68, v132, v128, s75
  v_mfma_f32_16x16x32_bf16 a[188:191], v[84:87], a[236:239], a[188:191]
  v_perm_b32 v65, v140, v136, s74
  v_perm_b32 v69, v140, v136, s75
  v_mfma_f32_16x16x32_bf16 a[192:195], v[84:87], a[240:243], a[192:195]
  v_perm_b32 v66, v148, v144, s74
  v_perm_b32 v70, v148, v144, s75
  v_mfma_f32_16x16x32_bf16 a[196:199], v[84:87], a[244:247], a[196:199]
  v_perm_b32 v67, v156, v152, s74
  v_perm_b32 v71, v156, v152, s75
  v_mfma_f32_16x16x32_bf16 a[200:203], v[88:91], a[236:239], a[200:203]
  v_perm_b32 v72, v133, v129, s74
  v_perm_b32 v76, v133, v129, s75
  v_mfma_f32_16x16x32_bf16 a[204:207], v[88:91], a[240:243], a[204:207]
  v_mfma_f32_16x16x32_bf16 a[208:211], v[88:91], a[244:247], a[208:211]
  buffer_load_dwordx4 v9, s[12:15], s83 offen offset:3072 lds
  v_mfma_f32_16x16x32_bf16 a[212:215], v[92:95], a[236:239], a[212:215]
  v_perm_b32 v73, v141, v137, s74
  v_perm_b32 v77, v141, v137, s75
  v_mfma_f32_16x16x32_bf16 a[216:219], v[92:95], a[240:243], a[216:219]
  v_perm_b32 v74, v149, v145, s74
  v_perm_b32 v78, v149, v145, s75
  v_mfma_f32_16x16x32_bf16 a[220:223], v[92:95], a[244:247], a[220:223]
  v_perm_b32 v75, v157, v153, s74
  v_perm_b32 v79, v157, v153, s75
  s_waitcnt lgkmcnt(0)
  v_mfma_f32_16x16x32_bf16 a[128:131], v[64:67], a[224:227], a[128:131]
  v_perm_b32 v80, v134, v130, s74
  v_perm_b32 v84, v134, v130, s75
  v_mfma_f32_16x16x32_bf16 a[132:135], v[64:67], a[228:231], a[132:135]
  v_mfma_f32_16x16x32_bf16 a[136:139], v[64:67], a[232:235], a[136:139]
  s_add_u32 s83, s65, 0
  buffer_load_dwordx4 a[32:35], v12, s[12:15], s83 offen offset:0
  v_mfma_f32_16x16x32_bf16 a[140:143], v[68:71], a[224:227], a[140:143]
  v_perm_b32 v81, v142, v138, s74
  v_perm_b32 v85, v142, v138, s75
  v_mfma_f32_16x16x32_bf16 a[144:147], v[68:71], a[228:231], a[144:147]
  v_perm_b32 v82, v150, v146, s74
  v_perm_b32 v86, v150, v146, s75
  v_mfma_f32_16x16x32_bf16 a[148:151], v[68:71], a[232:235], a[148:151]
  v_perm_b32 v83, v158, v154, s74
  v_perm_b32 v87, v158, v154, s75
  v_mfma_f32_16x16x32_bf16 a[152:155], v[72:75], a[224:227], a[152:155]
  v_perm_b32 v88, v135, v131, s74
  v_perm_b32 v92, v135, v131, s75
  v_mfma_f32_16x16x32_bf16 a[156:159], v[72:75], a[228:231], a[156:159]
  buffer_load_dwordx4 a[36:39], v12, s[12:15], s83 offen offset:1024
  v_mfma_f32_16x16x32_bf16 a[160:163], v[72:75], a[232:235], a[160:163]
  v_xor_b32 v61, 448, v2
  v_mfma_f32_16x16x32_bf16 a[164:167], v[76:79], a[224:227], a[164:167]
  v_perm_b32 v89, v143, v139, s74
  v_perm_b32 v93, v143, v139, s75
  ds_read_b128 a[236:239], v61 offset:0
  v_mfma_f32_16x16x32_bf16 a[168:171], v[76:79], a[228:231], a[168:171]
  v_perm_b32 v90, v151, v147, s74
  v_perm_b32 v94, v151, v147, s75
  ds_read_b128 a[240:243], v61 offset:16384
  v_mfma_f32_16x16x32_bf16 a[172:175], v[76:79], a[232:235], a[172:175]
  v_perm_b32 v91, v159, v155, s74
  v_perm_b32 v95, v159, v155, s75
  ds_read_b128 a[244:247], v61 offset:32768
  s_cmp_lg_u32 s72, 0
  s_cbranch_scc1 L_p1k1
  v_mfma_f32_16x16x32_bf16 a[176:179], v[80:83], a[224:227], a[176:179]
  v_mfma_f32_16x16x32_bf16 a[180:183], v[80:83], a[228:231], a[180:183]
  buffer_load_dwordx4 a[40:43], v12, s[12:15], s83 offen offset:2048
  v_mfma_f32_16x16x32_bf16 a[184:187], v[80:83], a[232:235], a[184:187]
  s_waitcnt vmcnt(11)
  v_perm_b32 v64, v166, v162, s74
  v_perm_b32 v68, v166, v162, s75
  v_mfma_f32_16x16x32_bf16 a[188:191], v[84:87], a[224:227], a[188:191]
  v_perm_b32 v65, v174, v170, s74
  v_perm_b32 v69, v174, v170, s75
  v_mfma_f32_16x16x32_bf16 a[192:195], v[84:87], a[228:231], a[192:195]
  v_perm_b32 v66, v182, v178, s74
  v_perm_b32 v70, v182, v178, s75
  v_mfma_f32_16x16x32_bf16 a[196:199], v[84:87], a[232:235], a[196:199]
  v_perm_b32 v67, v190, v186, s74
  v_perm_b32 v71, v190, v186, s75
  v_mfma_f32_16x16x32_bf16 a[200:203], v[88:91], a[224:227], a[200:203]
  v_perm_b32 v72, v167, v163, s74
  v_perm_b32 v76, v167, v163, s75
  v_mfma_f32_16x16x32_bf16 a[204:207], v[88:91], a[228:231], a[204:207]
  v_mfma_f32_16x16x32_bf16 a[208:211], v[88:91], a[232:235], a[208:211]
  buffer_load_dwordx4 a[44:47], v12, s[12:15], s83 offen offset:3072
  v_mfma_f32_16x16x32_bf16 a[212:215], v[92:95], a[224:227], a[212:215]
  v_perm_b32 v73, v175, v171, s74
  v_perm_b32 v77, v175, v171, s75
  v_mfma_f32_16x16x32_bf16 a[216:219], v[92:95], a[228:231], a[216:219]
  v_perm_b32 v74, v183, v179, s74
  v_perm_b32 v78, v183, v179, s75
  v_mfma_f32_16x16x32_bf16 a[220:223], v[92:95], a[232:235], a[220:223]
  v_perm_b32 v75, v191, v187, s74
  v_perm_b32 v79, v191, v187, s75
  s_waitcnt lgkmcnt(0)
  v_mfma_f32_16x16x32_bf16 a[176:179], v[64:67], a[236:239], a[176:179]
  v_perm_b32 v80, v164, v160, s74
  v_perm_b32 v84, v164, v160, s75
  v_mfma_f32_16x16x32_bf16 a[180:183], v[64:67], a[240:243], a[180:183]
  v_mfma_f32_16x16x32_bf16 a[184:187], v[64:67], a[244:247], a[184:187]
  s_add_u32 s83, s65, 4096
  buffer_load_dwordx4 a[48:51], v12, s[12:15], s83 offen offset:0
  v_mfma_f32_16x16x32_bf16 a[188:191], v[68:71], a[236:239], a[188:191]
  v_perm_b32 v81, v172, v168, s74
  v_perm_b32 v85, v172, v168, s75
  v_mfma_f32_16x16x32_bf16 a[192:195], v[68:71], a[240:243], a[192:195]
  v_perm_b32 v82, v180, v176, s74
  v_perm_b32 v86, v180, v176, s75
  v_mfma_f32_16x16x32_bf16 a[196:199], v[68:71], a[244:247], a[196:199]
  v_perm_b32 v83, v188, v184, s74
  v_perm_b32 v87, v188, v184, s75
  v_mfma_f32_16x16x32_bf16 a[200:203], v[72:75], a[236:239], a[200:203]
  v_perm_b32 v88, v165, v161, s74
  v_perm_b32 v92, v165, v161, s75
  v_mfma_f32_16x16x32_bf16 a[204:207], v[72:75], a[240:243], a[204:207]
  v_mfma_f32_16x16x32_bf16 a[208:211], v[72:75], a[244:247], a[208:211]
  buffer_load_dwordx4 a[52:55], v12, s[12:15], s83 offen offset:1024
  v_mfma_f32_16x16x32_bf16 a[212:215], v[76:79], a[236:239], a[212:215]
  v_perm_b32 v89, v173, v169, s74
  v_perm_b32 v93, v173, v169, s75
  v_mfma_f32_16x16x32_bf16 a[216:219], v[76:79], a[240:243], a[216:219]
  v_perm_b32 v90, v181, v177, s74
  v_perm_b32 v94, v181, v177, s75
  v_mfma_f32_16x16x32_bf16 a[220:223], v[76:79], a[244:247], a[220:223]
  v_perm_b32 v91, v189, v185, s74
  v_perm_b32 v95, v189, v185, s75
  v_mfma_f32_16x16x32_bf16 a[128:131], v[80:83], a[236:239], a[128:131]
  buffer_load_dwordx4 a[56:59], v12, s[12:15], s83 offen offset:2048
  v_mfma_f32_16x16x32_bf16 a[132:135], v[80:83], a[240:243], a[132:135]
  ds_write_b128 v59, a[176:179] offset:0
  v_mfma_f32_16x16x32_bf16 a[136:139], v[80:83], a[244:247], a[136:139]
  ds_write_b128 v59, a[180:183] offset:1024
  v_mfma_f32_16x16x32_bf16 a[140:143], v[84:87], a[236:239], a[140:143]
  ds_write_b128 v59, a[184:187] offset:2048
  v_mfma_f32_16x16x32_bf16 a[144:147], v[84:87], a[240:243], a[144:147]
  ds_write_b128 v59, a[188:191] offset:3072
  ds_write_b128 v59, a[192:195] offset:4096
  v_mfma_f32_16x16x32_bf16 a[148:151], v[84:87], a[244:247], a[148:151]
  ds_write_b128 v59, a[196:199] offset:5120
  v_mfma_f32_16x16x32_bf16 a[152:155], v[88:91], a[236:239], a[152:155]
  buffer_load_dwordx4 a[60:63], v12, s[12:15], s83 offen offset:3072
  v_mfma_f32_16x16x32_bf16 a[156:159], v[88:91], a[240:243], a[156:159]
  ds_write_b128 v59, a[200:203] offset:6144
  v_mfma_f32_16x16x32_bf16 a[160:163], v[88:91], a[244:247], a[160:163]
  ds_write_b128 v59, a[204:207] offset:7168
  v_mfma_f32_16x16x32_bf16 a[164:167], v[92:95], a[236:239], a[164:167]
  ds_write_b128 v59, a[208:211] offset:8192
  v_mfma_f32_16x16x32_bf16 a[168:171], v[92:95], a[240:243], a[168:171]
  ds_write_b128 v59, a[212:215] offset:9216
  ds_write_b128 v59, a[216:219] offset:10240
  v_mfma_f32_16x16x32_bf16 a[172:175], v[92:95], a[244:247], a[172:175]
  ds_write_b128 v59, a[220:223] offset:11264
  s_waitcnt lgkmcnt(0)
  s_barrier
  ds_read_b128 v[160:163], v58 offset:0
  ds_read_b128 v[172:175], v58 offset:3072
  ds_read_b128 v[184:187], v58 offset:6144
  ds_read_b128 v[196:199], v58 offset:9216
  ds_read_b128 v[164:167], v58 offset:1024
  ds_read_b128 v[176:179], v58 offset:4096
  ds_read_b128 v[188:191], v58 offset:7168
  ds_read_b128 v[200:203], v58 offset:10240
  ds_read_b128 v[168:171], v58 offset:2048
  ds_read_b128 v[180:183], v58 offset:5120
  ds_read_b128 v[192:195], v58 offset:8192
  ds_read_b128 v[204:207], v58 offset:11264
  v_accvgpr_read_b32 v96, a128
  v_accvgpr_read_b32 v97, a129
  v_accvgpr_read_b32 v98, a130
  v_accvgpr_read_b32 v99, a131
  v_accvgpr_read_b32 v108, a140
  v_accvgpr_read_b32 v109, a141
  v_accvgpr_read_b32 v110, a142
  v_accvgpr_read_b32 v111, a143
  v_accvgpr_read_b32 v120, a152
  v_accvgpr_read_b32 v121, a153
  v_accvgpr_read_b32 v122, a154
  v_accvgpr_read_b32 v123, a155
  v_accvgpr_read_b32 v132, a164
  v_accvgpr_read_b32 v133, a165
  v_accvgpr_read_b32 v134, a166
  v_accvgpr_read_b32 v135, a167
  v_accvgpr_read_b32 v100, a132
  v_accvgpr_read_b32 v101, a133
  v_accvgpr_read_b32 v102, a134
  v_accvgpr_read_b32 v103, a135
  v_accvgpr_read_b32 v112, a144
  v_accvgpr_read_b32 v113, a145
  v_accvgpr_read_b32 v114, a146
  v_accvgpr_read_b32 v115, a147
  v_accvgpr_read_b32 v124, a156
  v_accvgpr_read_b32 v125, a157
  v_accvgpr_read_b32 v126, a158
  v_accvgpr_read_b32 v127, a159
  v_accvgpr_read_b32 v136, a168
  v_accvgpr_read_b32 v137, a169
  v_accvgpr_read_b32 v138, a170
  v_accvgpr_read_b32 v139, a171
  v_accvgpr_read_b32 v104, a136
  v_accvgpr_read_b32 v105, a137
  v_accvgpr_read_b32 v106, a138
  v_accvgpr_read_b32 v107, a139
  v_accvgpr_read_b32 v116, a148
  v_accvgpr_read_b32 v117, a149
  v_accvgpr_read_b32 v118, a150
  v_accvgpr_read_b32 v119, a151
  v_accvgpr_read_b32 v128, a160
  v_accvgpr_read_b32 v129, a161
  v_accvgpr_read_b32 v130, a162
  v_accvgpr_read_b32 v131, a163
  v_accvgpr_read_b32 v140, a172
  v_accvgpr_read_b32 v141, a173
  v_accvgpr_read_b32 v142, a174
  v_accvgpr_read_b32 v143, a175
  s_waitcnt vmcnt(8)
  v_xor_b32 v55, 0, v54
  ds_read_b128 a[0:3], v55
  v_xor_b32 v56, 32, v54
  ds_read_b128 a[4:7], v56
  v_xor_b32 v55, 64, v54
  ds_read_b128 a[8:11], v55
  v_xor_b32 v56, 96, v54
  ds_read_b128 a[12:15], v56
  v_xor_b32 v55, 128, v54
  ds_read_b128 a[16:19], v55
  v_xor_b32 v56, 160, v54
  ds_read_b128 a[20:23], v56
  v_xor_b32 v55, 192, v54
  ds_read_b128 a[24:27], v55
  v_xor_b32 v56, 224, v54
  ds_read_b128 a[28:31], v56
  s_waitcnt lgkmcnt(15)
  v_pk_add_f32 v[96:97], v[96:97], v[160:161]
  v_pk_add_f32 v[98:99], v[98:99], v[162:163]
  v_pk_add_f32 v[108:109], v[108:109], v[172:173]
  v_pk_add_f32 v[110:111], v[110:111], v[174:175]
  v_pk_add_f32 v[120:121], v[120:121], v[184:185]
  v_pk_add_f32 v[122:123], v[122:123], v[186:187]
  v_pk_add_f32 v[132:133], v[132:133], v[196:197]
  v_pk_add_f32 v[134:135], v[134:135], v[198:199]
  v_cvt_pk_bf16_f32 v208, v96, v108
  v_cvt_pk_bf16_f32 v209, v120, v132
  ds_write_b64 v16, v[208:209] offset:0
  v_cvt_pk_bf16_f32 v210, v97, v109
  v_cvt_pk_bf16_f32 v211, v121, v133
  ds_write_b64 v16, v[210:211] offset:512
  v_cvt_pk_bf16_f32 v212, v98, v110
  v_cvt_pk_bf16_f32 v213, v122, v134
  ds_write_b64 v16, v[212:213] offset:1024
  v_cvt_pk_bf16_f32 v214, v99, v111
  v_cvt_pk_bf16_f32 v215, v123, v135
  ds_write_b64 v16, v[214:215] offset:1536
  s_waitcnt lgkmcnt(15)
  v_pk_add_f32 v[100:101], v[100:101], v[164:165]
  v_pk_add_f32 v[102:103], v[102:103], v[166:167]
  v_pk_add_f32 v[112:113], v[112:113], v[176:177]
  v_pk_add_f32 v[114:115], v[114:115], v[178:179]
  v_pk_add_f32 v[124:125], v[124:125], v[188:189]
  v_pk_add_f32 v[126:127], v[126:127], v[190:191]
  v_pk_add_f32 v[136:137], v[136:137], v[200:201]
  v_pk_add_f32 v[138:139], v[138:139], v[202:203]
  v_cvt_pk_bf16_f32 v208, v100, v112
  v_cvt_pk_bf16_f32 v209, v124, v136
  ds_write_b64 v17, v[208:209] offset:0
  v_cvt_pk_bf16_f32 v210, v101, v113
  v_cvt_pk_bf16_f32 v211, v125, v137
  ds_write_b64 v17, v[210:211] offset:512
  v_cvt_pk_bf16_f32 v212, v102, v114
  v_cvt_pk_bf16_f32 v213, v126, v138
  ds_write_b64 v17, v[212:213] offset:1024
  v_cvt_pk_bf16_f32 v214, v103, v115
  v_cvt_pk_bf16_f32 v215, v127, v139
  ds_write_b64 v17, v[214:215] offset:1536
  s_waitcnt lgkmcnt(15)
  v_pk_add_f32 v[104:105], v[104:105], v[168:169]
  v_pk_add_f32 v[106:107], v[106:107], v[170:171]
  v_pk_add_f32 v[116:117], v[116:117], v[180:181]
  v_pk_add_f32 v[118:119], v[118:119], v[182:183]
  v_pk_add_f32 v[128:129], v[128:129], v[192:193]
  v_pk_add_f32 v[130:131], v[130:131], v[194:195]
  v_pk_add_f32 v[140:141], v[140:141], v[204:205]
  v_pk_add_f32 v[142:143], v[142:143], v[206:207]
  v_cvt_pk_bf16_f32 v208, v104, v116
  v_cvt_pk_bf16_f32 v209, v128, v140
  ds_write_b64 v18, v[208:209] offset:0
  v_cvt_pk_bf16_f32 v210, v105, v117
  v_cvt_pk_bf16_f32 v211, v129, v141
  ds_write_b64 v18, v[210:211] offset:512
  v_cvt_pk_bf16_f32 v212, v106, v118
  v_cvt_pk_bf16_f32 v213, v130, v142
  ds_write_b64 v18, v[212:213] offset:1024
  v_cvt_pk_bf16_f32 v214, v107, v119
  v_cvt_pk_bf16_f32 v215, v131, v143
  ds_write_b64 v18, v[214:215] offset:1536
  s_branch L_p1j
L_p1k1:
  v_mfma_f32_16x16x32_bf16 a[176:179], v[80:83], a[224:227], a[176:179]
  v_mfma_f32_16x16x32_bf16 a[180:183], v[80:83], a[228:231], a[180:183]
  buffer_load_dwordx4 a[40:43], v12, s[12:15], s83 offen offset:2048
  v_mfma_f32_16x16x32_bf16 a[184:187], v[80:83], a[232:235], a[184:187]
  s_waitcnt vmcnt(11)
  v_perm_b32 v64, v164, v160, s74
  v_perm_b32 v68, v164, v160, s75
  v_mfma_f32_16x16x32_bf16 a[188:191], v[84:87], a[224:227], a[188:191]
  v_perm_b32 v65, v172, v168, s74
  v_perm_b32 v69, v172, v168, s75
  v_mfma_f32_16x16x32_bf16 a[192:195], v[84:87], a[228:231], a[192:195]
  v_perm_b32 v66, v180, v176, s74
  v_perm_b32 v70, v180, v176, s75
  v_mfma_f32_16x16x32_bf16 a[196:199], v[84:87], a[232:235], a[196:199]
  v_perm_b32 v67, v188, v184, s74
  v_perm_b32 v71, v188, v184, s75
  v_mfma_f32_16x16x32_bf16 a[200:203], v[88:91], a[224:227], a[200:203]
  v_perm_b32 v72, v165, v161, s74
  v_perm_b32 v76, v165, v161, s75
  v_mfma_f32_16x16x32_bf16 a[204:207], v[88:91], a[228:231], a[204:207]
  v_mfma_f32_16x16x32_bf16 a[208:211], v[88:91], a[232:235], a[208:211]
  buffer_load_dwordx4 a[44:47], v12, s[12:15], s83 offen offset:3072
  v_mfma_f32_16x16x32_bf16 a[212:215], v[92:95], a[224:227], a[212:215]
  v_perm_b32 v73, v173, v169, s74
  v_perm_b32 v77, v173, v169, s75
  v_mfma_f32_16x16x32_bf16 a[216:219], v[92:95], a[228:231], a[216:219]
  v_perm_b32 v74, v181, v177, s74
  v_perm_b32 v78, v181, v177, s75
  v_mfma_f32_16x16x32_bf16 a[220:223], v[92:95], a[232:235], a[220:223]
  v_perm_b32 v75, v189, v185, s74
  v_perm_b32 v79, v189, v185, s75
  s_waitcnt lgkmcnt(0)
  v_mfma_f32_16x16x32_bf16 a[128:131], v[64:67], a[236:239], a[128:131]
  v_perm_b32 v80, v166, v162, s74
  v_perm_b32 v84, v166, v162, s75
  v_mfma_f32_16x16x32_bf16 a[132:135], v[64:67], a[240:243], a[132:135]
  v_mfma_f32_16x16x32_bf16 a[136:139], v[64:67], a[244:247], a[136:139]
  s_add_u32 s83, s65, 4096
  buffer_load_dwordx4 a[48:51], v12, s[12:15], s83 offen offset:0
  v_mfma_f32_16x16x32_bf16 a[140:143], v[68:71], a[236:239], a[140:143]
  v_perm_b32 v81, v174, v170, s74
  v_perm_b32 v85, v174, v170, s75
  v_mfma_f32_16x16x32_bf16 a[144:147], v[68:71], a[240:243], a[144:147]
  v_perm_b32 v82, v182, v178, s74
  v_perm_b32 v86, v182, v178, s75
  v_mfma_f32_16x16x32_bf16 a[148:151], v[68:71], a[244:247], a[148:151]
  v_perm_b32 v83, v190, v186, s74
  v_perm_b32 v87, v190, v186, s75
  v_mfma_f32_16x16x32_bf16 a[152:155], v[72:75], a[236:239], a[152:155]
  v_perm_b32 v88, v167, v163, s74
  v_perm_b32 v92, v167, v163, s75
  v_mfma_f32_16x16x32_bf16 a[156:159], v[72:75], a[240:243], a[156:159]
  v_mfma_f32_16x16x32_bf16 a[160:163], v[72:75], a[244:247], a[160:163]
  buffer_load_dwordx4 a[52:55], v12, s[12:15], s83 offen offset:1024
  v_mfma_f32_16x16x32_bf16 a[164:167], v[76:79], a[236:239], a[164:167]
  v_perm_b32 v89, v175, v171, s74
  v_perm_b32 v93, v175, v171, s75
  v_mfma_f32_16x16x32_bf16 a[168:171], v[76:79], a[240:243], a[168:171]
  v_perm_b32 v90, v183, v179, s74
  v_perm_b32 v94, v183, v179, s75
  v_mfma_f32_16x16x32_bf16 a[172:175], v[76:79], a[244:247], a[172:175]
  v_perm_b32 v91, v191, v187, s74
  v_perm_b32 v95, v191, v187, s75
  v_mfma_f32_16x16x32_bf16 a[176:179], v[80:83], a[236:239], a[176:179]
  buffer_load_dwordx4 a[56:59], v12, s[12:15], s83 offen offset:2048
  v_mfma_f32_16x16x32_bf16 a[180:183], v[80:83], a[240:243], a[180:183]
  ds_write_b128 v59, a[128:131] offset:0
  v_mfma_f32_16x16x32_bf16 a[184:187], v[80:83], a[244:247], a[184:187]
  ds_write_b128 v59, a[132:135] offset:1024
  v_mfma_f32_16x16x32_bf16 a[188:191], v[84:87], a[236:239], a[188:191]
  ds_write_b128 v59, a[136:139] offset:2048
  v_mfma_f32_16x16x32_bf16 a[192:195], v[84:87], a[240:243], a[192:195]
  ds_write_b128 v59, a[140:143] offset:3072
  ds_write_b128 v59, a[144:147] offset:4096
  v_mfma_f32_16x16x32_bf16 a[196:199], v[84:87], a[244:247], a[196:199]
  ds_write_b128 v59, a[148:151] offset:5120
  v_mfma_f32_16x16x32_bf16 a[200:203], v[88:91], a[236:239], a[200:203]
  buffer_load_dwordx4 a[60:63], v12, s[12:15], s83 offen offset:3072
  v_mfma_f32_16x16x32_bf16 a[204:207], v[88:91], a[240:243], a[204:207]
  ds_write_b128 v59, a[152:155] offset:6144
  v_mfma_f32_16x16x32_bf16 a[208:211], v[88:91], a[244:247], a[208:211]
  ds_write_b128 v59, a[156:159] offset:7168
  v_mfma_f32_16x16x32_bf16 a[212:215], v[92:95], a[236:239], a[212:215]
  ds_write_b128 v59, a[160:163] offset:8192
  v_mfma_f32_16x16x32_bf16 a[216:219], v[92:95], a[240:243], a[216:219]
  ds_write_b128 v59, a[164:167] offset:9216
  ds_write_b128 v59, a[168:171] offset:10240
  v_mfma_f32_16x16x32_bf16 a[220:223], v[92:95], a[244:247], a[220:223]
  ds_write_b128 v59, a[172:175] offset:11264
  s_waitcnt lgkmcnt(0)
  s_barrier
  ds_read_b128 v[160:163], v58 offset:0
  ds_read_b128 v[172:175], v58 offset:3072
  ds_read_b128 v[184:187], v58 offset:6144
  ds_read_b128 v[196:199], v58 offset:9216
  ds_read_b128 v[164:167], v58 offset:1024
  ds_read_b128 v[176:179], v58 offset:4096
  ds_read_b128 v[188:191], v58 offset:7168
  ds_read_b128 v[200:203], v58 offset:10240
  ds_read_b128 v[168:171], v58 offset:2048
  ds_read_b128 v[180:183], v58 offset:5120
  ds_read_b128 v[192:195], v58 offset:8192
  ds_read_b128 v[204:207], v58 offset:11264
  v_accvgpr_read_b32 v96, a176
  v_accvgpr_read_b32 v97, a177
  v_accvgpr_read_b32 v98, a178
  v_accvgpr_read_b32 v99, a179
  v_accvgpr_read_b32 v108, a188
  v_accvgpr_read_b32 v109, a189
  v_accvgpr_read_b32 v110, a190
  v_accvgpr_read_b32 v111, a191
  v_accvgpr_read_b32 v120, a200
  v_accvgpr_read_b32 v121, a201
  v_accvgpr_read_b32 v122, a202
  v_accvgpr_read_b32 v123, a203
  v_accvgpr_read_b32 v132, a212
  v_accvgpr_read_b32 v133, a213
  v_accvgpr_read_b32 v134, a214
  v_accvgpr_read_b32 v135, a215
  v_accvgpr_read_b32 v100, a180
  v_accvgpr_read_b32 v101, a181
  v_accvgpr_read_b32 v102, a182
  v_accvgpr_read_b32 v103, a183
  v_accvgpr_read_b32 v112, a192
  v_accvgpr_read_b32 v113, a193
  v_accvgpr_read_b32 v114, a194
  v_accvgpr_read_b32 v115, a195
  v_accvgpr_read_b32 v124, a204
  v_accvgpr_read_b32 v125, a205
  v_accvgpr_read_b32 v126, a206
  v_accvgpr_read_b32 v127, a207
  v_accvgpr_read_b32 v136, a216
  v_accvgpr_read_b32 v137, a217
  v_accvgpr_read_b32 v138, a218
  v_accvgpr_read_b32 v139, a219
  v_accvgpr_read_b32 v104, a184
  v_accvgpr_read_b32 v105, a185
  v_accvgpr_read_b32 v106, a186
  v_accvgpr_read_b32 v107, a187
  v_accvgpr_read_b32 v116, a196
  v_accvgpr_read_b32 v117, a197
  v_accvgpr_read_b32 v118, a198
  v_accvgpr_read_b32 v119, a199
  v_accvgpr_read_b32 v128, a208
  v_accvgpr_read_b32 v129, a209
  v_accvgpr_read_b32 v130, a210
  v_accvgpr_read_b32 v131, a211
  v_accvgpr_read_b32 v140, a220
  v_accvgpr_read_b32 v141, a221
  v_accvgpr_read_b32 v142, a222
  v_accvgpr_read_b32 v143, a223
  s_waitcnt vmcnt(8)
  v_xor_b32 v55, 0, v54
  ds_read_b128 a[0:3], v55
  v_xor_b32 v56, 32, v54
  ds_read_b128 a[4:7], v56
  v_xor_b32 v55, 64, v54
  ds_read_b128 a[8:11], v55
  v_xor_b32 v56, 96, v54
  ds_read_b128 a[12:15], v56
  v_xor_b32 v55, 128, v54
  ds_read_b128 a[16:19], v55
  v_xor_b32 v56, 160, v54
  ds_read_b128 a[20:23], v56
  v_xor_b32 v55, 192, v54
  ds_read_b128 a[24:27], v55
  v_xor_b32 v56, 224, v54
  ds_read_b128 a[28:31], v56
  s_waitcnt lgkmcnt(15)
  v_pk_add_f32 v[96:97], v[96:97], v[160:161]
  v_pk_add_f32 v[98:99], v[98:99], v[162:163]
  v_pk_add_f32 v[108:109], v[108:109], v[172:173]
  v_pk_add_f32 v[110:111], v[110:111], v[174:175]
  v_pk_add_f32 v[120:121], v[120:121], v[184:185]
  v_pk_add_f32 v[122:123], v[122:123], v[186:187]
  v_pk_add_f32 v[132:133], v[132:133], v[196:197]
  v_pk_add_f32 v[134:135], v[134:135], v[198:199]
  v_cvt_pk_bf16_f32 v208, v96, v108
  v_cvt_pk_bf16_f32 v209, v120, v132
  ds_write_b64 v16, v[208:209] offset:0
  v_cvt_pk_bf16_f32 v210, v97, v109
  v_cvt_pk_bf16_f32 v211, v121, v133
  ds_write_b64 v16, v[210:211] offset:512
  v_cvt_pk_bf16_f32 v212, v98, v110
  v_cvt_pk_bf16_f32 v213, v122, v134
  ds_write_b64 v16, v[212:213] offset:1024
  v_cvt_pk_bf16_f32 v214, v99, v111
  v_cvt_pk_bf16_f32 v215, v123, v135
  ds_write_b64 v16, v[214:215] offset:1536
  s_waitcnt lgkmcnt(15)
  v_pk_add_f32 v[100:101], v[100:101], v[164:165]
  v_pk_add_f32 v[102:103], v[102:103], v[166:167]
  v_pk_add_f32 v[112:113], v[112:113], v[176:177]
  v_pk_add_f32 v[114:115], v[114:115], v[178:179]
  v_pk_add_f32 v[124:125], v[124:125], v[188:189]
  v_pk_add_f32 v[126:127], v[126:127], v[190:191]
  v_pk_add_f32 v[136:137], v[136:137], v[200:201]
  v_pk_add_f32 v[138:139], v[138:139], v[202:203]
  v_cvt_pk_bf16_f32 v208, v100, v112
  v_cvt_pk_bf16_f32 v209, v124, v136
  ds_write_b64 v17, v[208:209] offset:0
  v_cvt_pk_bf16_f32 v210, v101, v113
  v_cvt_pk_bf16_f32 v211, v125, v137
  ds_write_b64 v17, v[210:211] offset:512
  v_cvt_pk_bf16_f32 v212, v102, v114
  v_cvt_pk_bf16_f32 v213, v126, v138
  ds_write_b64 v17, v[212:213] offset:1024
  v_cvt_pk_bf16_f32 v214, v103, v115
  v_cvt_pk_bf16_f32 v215, v127, v139
  ds_write_b64 v17, v[214:215] offset:1536
  s_waitcnt lgkmcnt(15)
  v_pk_add_f32 v[104:105], v[104:105], v[168:169]
  v_pk_add_f32 v[106:107], v[106:107], v[170:171]
  v_pk_add_f32 v[116:117], v[116:117], v[180:181]
  v_pk_add_f32 v[118:119], v[118:119], v[182:183]
  v_pk_add_f32 v[128:129], v[128:129], v[192:193]
  v_pk_add_f32 v[130:131], v[130:131], v[194:195]
  v_pk_add_f32 v[140:141], v[140:141], v[204:205]
  v_pk_add_f32 v[142:143], v[142:143], v[206:207]
  v_cvt_pk_bf16_f32 v208, v104, v116
  v_cvt_pk_bf16_f32 v209, v128, v140
  ds_write_b64 v18, v[208:209] offset:0
  v_cvt_pk_bf16_f32 v210, v105, v117
  v_cvt_pk_bf16_f32 v211, v129, v141
  ds_write_b64 v18, v[210:211] offset:512
  v_cvt_pk_bf16_f32 v212, v106, v118
  v_cvt_pk_bf16_f32 v213, v130, v142
  ds_write_b64 v18, v[212:213] offset:1024
  v_cvt_pk_bf16_f32 v214, v107, v119
  v_cvt_pk_bf16_f32 v215, v131, v143
  ds_write_b64 v18, v[214:215] offset:1536
L_p1j:
  s_waitcnt lgkmcnt(0)
  s_barrier
  ds_read_b128 a[128:131], v11 offset:24576
  ds_read_b128 a[132:135], v11 offset:25600
  ds_read_b128 a[136:139], v11 offset:26624
  ds_read_b128 a[140:143], v11 offset:27648
  ds_read_b128 a[144:147], v11 offset:28672
  ds_read_b128 a[148:151], v11 offset:29696
  ds_read_b128 a[152:155], v11 offset:30720
  ds_read_b128 a[156:159], v11 offset:31744
  ds_read_b128 a[160:163], v11 offset:32768
  ds_read_b128 a[164:167], v11 offset:33792
  ds_read_b128 a[168:171], v11 offset:34816
  ds_read_b128 a[172:175], v11 offset:35840
  ds_read_b128 a[176:179], v11 offset:36864
  ds_read_b128 a[180:183], v11 offset:37888
  ds_read_b128 a[184:187], v11 offset:38912
  ds_read_b128 a[188:191], v11 offset:39936
  ds_read_b128 a[192:195], v11 offset:40960
  ds_read_b128 a[196:199], v11 offset:41984
  ds_read_b128 a[200:203], v11 offset:43008
  ds_read_b128 a[204:207], v11 offset:44032
  ds_read_b128 a[208:211], v11 offset:45056
  ds_read_b128 a[212:215], v11 offset:46080
  ds_read_b128 a[216:219], v11 offset:47104
  ds_read_b128 a[220:223], v11 offset:48128
  v_add_u32 v2, 81920, v54
  v_add_u32 v60, 0x14000, v19
  v_add_u32 v61, 0x14000, v20
  v_add_u32 v10, 0x8000, v14
  s_waitcnt lgkmcnt(15)
  v_mfma_f32_32x32x16_bf16 v[64:79], a[0:3], a[128:131], 0
  s_waitcnt vmcnt(0)
  s_add_u32 m0, s76, 49152
  s_add_u32 s83, s64, 0
  buffer_load_dwordx4 v13, s[16:19], s83 offen offset:0 lds
  ds_write_b128 v6, a[32:35] offset:49152
  v_mfma_f32_32x32x16_bf16 v[64:79], a[4:7], a[132:135], v[64:79]
  ds_write_b128 v7, a[36:39] offset:50176
  ds_write_b128 v8, a[40:43] offset:51200
  v_mfma_f32_32x32x16_bf16 v[64:79], a[8:11], a[136:139], v[64:79]
  ds_write_b128 v9, a[44:47] offset:52224
  buffer_load_dwordx4 v13, s[16:19], s83 offen offset:1024 lds
  v_mfma_f32_32x32x16_bf16 v[64:79], a[12:15], a[140:143], v[64:79]
  ds_write_b128 v6, a[48:51] offset:53248
  ds_write_b128 v7, a[52:55] offset:54272
  v_mfma_f32_32x32x16_bf16 v[64:79], a[16:19], a[144:147], v[64:79]
  ds_write_b128 v8, a[56:59] offset:55296
  ds_write_b128 v9, a[60:63] offset:56320
  buffer_load_dwordx4 v13, s[16:19], s83 offen offset:2048 lds
  v_mfma_f32_32x32x16_bf16 v[64:79], a[20:23], a[148:151], v[64:79]
  v_xor_b32 v55, 0, v54
  ds_read_b128 a[32:35], v55
  v_xor_b32 v56, 32, v54
  ds_read_b128 a[36:39], v56
  v_xor_b32 v55, 64, v54
  ds_read_b128 a[40:43], v55
  v_mfma_f32_32x32x16_bf16 v[64:79], a[24:27], a[152:155], v[64:79]
  v_xor_b32 v56, 96, v54
  ds_read_b128 a[44:47], v56
  buffer_load_dwordx4 v13, s[16:19], s83 offen offset:3072 lds
  v_mfma_f32_32x32x16_bf16 v[64:79], a[28:31], a[156:159], v[64:79]
  v_xor_b32 v55, 128, v54
  ds_read_b128 a[48:51], v55
  v_xor_b32 v56, 160, v54
  ds_read_b128 a[52:55], v56
  v_xor_b32 v55, 192, v54
  ds_read_b128 a[56:59], v55
  v_xor_b32 v56, 224, v54
  ds_read_b128 a[60:63], v56
  s_waitcnt lgkmcnt(0)
  v_mfma_f32_32x32x16_bf16 v[80:95], a[32:35], a[128:131], 0
  s_nop 1
  v_max_f32 v62, v64, v65
  v_max3_f32 v62, v66, v67, v62
  v_mfma_f32_32x32x16_bf16 v[80:95], a[36:39], a[132:135], v[80:95]
  v_max3_f32 v62, v68, v69, v62
  v_mfma_f32_32x32x16_bf16 v[80:95], a[40:43], a[136:139], v[80:95]
  v_max3_f32 v62, v70, v71, v62
  v_max3_f32 v62, v72, v73, v62
  v_mfma_f32_32x32x16_bf16 v[80:95], a[44:47], a[140:143], v[80:95]
  v_max3_f32 v62, v74, v75, v62
  v_mfma_f32_32x32x16_bf16 v[80:95], a[48:51], a[144:147], v[80:95]
  v_max3_f32 v62, v76, v77, v62
  v_max3_f32 v62, v78, v79, v62
  v_mfma_f32_32x32x16_bf16 v[80:95], a[52:55], a[148:151], v[80:95]
  v_mfma_f32_32x32x16_bf16 v[80:95], a[56:59], a[152:155], v[80:95]
  s_add_u32 m0, s76, 0
  s_add_u32 s83, s78, 0
  buffer_load_dwordx4 v6, s[12:15], s83 offen offset:0 lds
  v_mfma_f32_32x32x16_bf16 v[80:95], a[60:63], a[156:159], v[80:95]
  buffer_load_dwordx4 v7, s[12:15], s83 offen offset:1024 lds
  buffer_load_dwordx4 v8, s[12:15], s83 offen offset:2048 lds
  buffer_load_dwordx4 v9, s[12:15], s83 offen offset:3072 lds
  s_nop 8
  v_max3_f32 v62, v80, v81, v62
  v_max3_f32 v62, v82, v83, v62
  v_max3_f32 v62, v84, v85, v62
  v_max3_f32 v62, v86, v87, v62
  v_max3_f32 v62, v88, v89, v62
  v_max3_f32 v62, v90, v91, v62
  v_max3_f32 v62, v92, v93, v62
  v_max3_f32 v62, v94, v95, v62
  ds_write_b32 v60, v62 offset:0
  s_waitcnt lgkmcnt(0)
  s_barrier
  ds_read_b128 v[46:49], v61 offset:0
  ds_read_b128 v[50:53], v61 offset:16
  v_mfma_f32_32x32x16_bf16 v[128:143], a[0:3], a[160:163], 0
  v_mfma_f32_32x32x16_bf16 v[128:143], a[4:7], a[164:167], v[128:143]
  v_mfma_f32_32x32x16_bf16 v[128:143], a[8:11], a[168:171], v[128:143]
  s_waitcnt lgkmcnt(0)
  v_max3_f32 v46, v46, v47, v48
  v_max3_f32 v50, v50, v51, v52
  v_max3_f32 v46, v46, v49, v53
  v_max_f32 v46, v46, v50
  v_mul_f32 v21, s36, v46
  v_fma_f32 v64, v64, s36, -v21
  s_add_u32 m0, s76, 4096
  s_add_u32 s83, s78, 4096
  buffer_load_dwordx4 v6, s[12:15], s83 offen offset:0 lds
  v_fma_f32 v65, v65, s36, -v21
  v_fma_f32 v66, v66, s36, -v21
  v_fma_f32 v67, v67, s36, -v21
  v_fma_f32 v68, v68, s36, -v21
  v_fma_f32 v69, v69, s36, -v21
  v_fma_f32 v70, v70, s36, -v21
  v_fma_f32 v71, v71, s36, -v21
  v_exp_f32 v64, v64
  v_exp_f32 v65, v65
  v_exp_f32 v66, v66
  v_exp_f32 v67, v67
  v_exp_f32 v68, v68
  v_mfma_f32_32x32x16_bf16 v[128:143], a[12:15], a[172:175], v[128:143]
  v_exp_f32 v69, v69
  v_exp_f32 v70, v70
  buffer_load_dwordx4 v7, s[12:15], s83 offen offset:1024 lds
  v_exp_f32 v71, v71
  v_mfma_f32_32x32x16_bf16 v[128:143], a[16:19], a[176:179], v[128:143]
  v_add_f32 v24, v64, v65
  v_cvt_pk_bf16_f32 v30, v64, v65
  v_add_f32 v24, v66, v24
  v_add_f32 v24, v67, v24
  v_cvt_pk_bf16_f32 v31, v66, v67
  v_add_f32 v24, v68, v24
  v_add_f32 v24, v69, v24
  v_cvt_pk_bf16_f32 v32, v68, v69
  v_add_f32 v24, v70, v24
  v_mfma_f32_32x32x16_bf16 v[128:143], a[20:23], a[180:183], v[128:143]
  v_add_f32 v24, v71, v24
  v_cvt_pk_bf16_f32 v33, v70, v71
  ds_write_b128 v15, v[30:33] offset:0
  v_fma_f32 v72, v72, s36, -v21
  buffer_load_dwordx4 v8, s[12:15], s83 offen offset:2048 lds
  v_mfma_f32_32x32x16_bf16 v[128:143], a[24:27], a[184:187], v[128:143]
  v_fma_f32 v73, v73, s36, -v21
  v_fma_f32 v74, v74, s36, -v21
  v_fma_f32 v75, v75, s36, -v21
  v_fma_f32 v76, v76, s36, -v21
  v_fma_f32 v77, v77, s36, -v21
  v_fma_f32 v78, v78, s36, -v21
  v_fma_f32 v79, v79, s36, -v21
  v_mfma_f32_32x32x16_bf16 v[128:143], a[28:31], a[188:191], v[128:143]
  v_exp_f32 v72, v72
  v_exp_f32 v73, v73
  v_exp_f32 v74, v74
  v_exp_f32 v75, v75
  v_exp_f32 v76, v76
  v_mfma_f32_32x32x16_bf16 v[144:159], a[32:35], a[160:163], 0
  s_nop 5
  v_max_f32 v62, v128, v129
  v_max3_f32 v62, v130, v131, v62
  v_max3_f32 v62, v132, v133, v62
  v_max3_f32 v62, v134, v135, v62
  v_max3_f32 v62, v136, v137, v62
  v_max3_f32 v62, v138, v139, v62
  v_max3_f32 v62, v140, v141, v62
  v_max3_f32 v62, v142, v143, v62
  v_exp_f32 v77, v77
  v_mfma_f32_32x32x16_bf16 v[144:159], a[36:39], a[164:167], v[144:159]
  v_exp_f32 v78, v78
  buffer_load_dwordx4 v9, s[12:15], s83 offen offset:3072 lds
  v_exp_f32 v79, v79
  v_mfma_f32_32x32x16_bf16 v[144:159], a[40:43], a[168:171], v[144:159]
  v_add_f32 v24, v72, v24
  v_add_f32 v24, v73, v24
  v_cvt_pk_bf16_f32 v34, v72, v73
  v_add_f32 v24, v74, v24
  v_add_f32 v24, v75, v24
  v_cvt_pk_bf16_f32 v35, v74, v75
  v_add_f32 v24, v76, v24
  v_add_f32 v24, v77, v24
  v_cvt_pk_bf16_f32 v36, v76, v77
  v_mfma_f32_32x32x16_bf16 v[144:159], a[44:47], a[172:175], v[144:159]
  v_add_f32 v24, v78, v24
  v_add_f32 v24, v79, v24
  v_cvt_pk_bf16_f32 v37, v78, v79
  ds_write_b128 v15, v[34:37] offset:1024
  v_fma_f32 v80, v80, s36, -v21
  v_mfma_f32_32x32x16_bf16 v[144:159], a[48:51], a[176:179], v[144:159]
  s_add_u32 m0, s76, 53248
  s_add_u32 s83, s64, 4096
  buffer_load_dwordx4 v13, s[16:19], s83 offen offset:0 lds
  v_fma_f32 v81, v81, s36, -v21
  v_fma_f32 v82, v82, s36, -v21
  v_fma_f32 v83, v83, s36, -v21
  v_fma_f32 v84, v84, s36, -v21
  v_fma_f32 v85, v85, s36, -v21
  v_fma_f32 v86, v86, s36, -v21
  v_fma_f32 v87, v87, s36, -v21
  v_mfma_f32_32x32x16_bf16 v[144:159], a[52:55], a[180:183], v[144:159]
  v_exp_f32 v80, v80
  v_exp_f32 v81, v81
  v_exp_f32 v82, v82
  v_exp_f32 v83, v83
  v_exp_f32 v84, v84
  v_mfma_f32_32x32x16_bf16 v[144:159], a[56:59], a[184:187], v[144:159]
  v_exp_f32 v85, v85
  v_exp_f32 v86, v86
  buffer_load_dwordx4 v13, s[16:19], s83 offen offset:1024 lds
  v_mfma_f32_32x32x16_bf16 v[144:159], a[60:63], a[188:191], v[144:159]
  v_exp_f32 v87, v87
  v_add_f32 v24, v80, v24
  v_add_f32 v24, v81, v24
  v_cvt_pk_bf16_f32 v38, v80, v81
  v_add_f32 v24, v82, v24
  v_add_f32 v24, v83, v24
  v_cvt_pk_bf16_f32 v39, v82, v83
  v_add_f32 v24, v84, v24
  v_add_f32 v24, v85, v24
  v_cvt_pk_bf16_f32 v40, v84, v85
  v_add_f32 v24, v86, v24
  v_add_f32 v24, v87, v24
  v_cvt_pk_bf16_f32 v41, v86, v87
  ds_write_b128 v15, v[38:41] offset:8192
  v_fma_f32 v88, v88, s36, -v21
  buffer_load_dwordx4 v13, s[16:19], s83 offen offset:2048 lds
  v_fma_f32 v89, v89, s36, -v21
  v_fma_f32 v90, v90, s36, -v21
  v_fma_f32 v91, v91, s36, -v21
  v_fma_f32 v92, v92, s36, -v21
  v_max3_f32 v62, v144, v145, v62
  v_fma_f32 v93, v93, s36, -v21
  v_max3_f32 v62, v146, v147, v62
  v_fma_f32 v94, v94, s36, -v21
  v_max3_f32 v62, v148, v149, v62
  v_fma_f32 v95, v95, s36, -v21
  v_max3_f32 v62, v150, v151, v62
  v_exp_f32 v88, v88
  v_max3_f32 v62, v152, v153, v62
  v_exp_f32 v89, v89
  v_max3_f32 v62, v154, v155, v62
  v_exp_f32 v90, v90
  v_max3_f32 v62, v156, v157, v62
  v_exp_f32 v91, v91
  v_max3_f32 v62, v158, v159, v62
  v_exp_f32 v92, v92
  ds_write_b32 v60, v62 offset:1024
  v_exp_f32 v93, v93
  v_exp_f32 v94, v94
  buffer_load_dwordx4 v13, s[16:19], s83 offen offset:3072 lds
  v_exp_f32 v95, v95
  v_cvt_pk_bf16_f32 v42, v88, v89
  v_cvt_pk_bf16_f32 v43, v90, v91
  v_cvt_pk_bf16_f32 v44, v92, v93
  v_cvt_pk_bf16_f32 v45, v94, v95
  ds_write_b128 v15, v[42:45] offset:9216
  v_add_f32 v24, v88, v24
  v_add_f32 v24, v89, v24
  v_add_f32 v24, v90, v24
  v_add_f32 v24, v91, v24
  v_add_f32 v24, v92, v24
  v_add_f32 v24, v93, v24
  v_add_f32 v24, v94, v24
  v_add_f32 v24, v95, v24
  s_waitcnt lgkmcnt(0)
  s_barrier
  ds_read_b128 v[46:49], v61 offset:1024
  ds_read_b128 v[50:53], v61 offset:1040
  v_mfma_f32_32x32x16_bf16 v[64:79], a[0:3], a[192:195], 0
  v_mfma_f32_32x32x16_bf16 v[64:79], a[4:7], a[196:199], v[64:79]
  v_mfma_f32_32x32x16_bf16 v[64:79], a[8:11], a[200:203], v[64:79]
  s_waitcnt lgkmcnt(0)
  v_max3_f32 v46, v46, v47, v48
  v_max3_f32 v50, v50, v51, v52
  v_max3_f32 v46, v46, v49, v53
  v_max_f32 v46, v46, v50
  v_mul_f32 v22, s36, v46
  v_fma_f32 v128, v128, s36, -v22
  s_add_u32 m0, s76, 81920
  s_add_u32 s83, s79, 0
  buffer_load_dwordx4 v6, s[12:15], s83 offen offset:0 lds
  v_fma_f32 v129, v129, s36, -v22
  v_fma_f32 v130, v130, s36, -v22
  v_fma_f32 v131, v131, s36, -v22
  v_fma_f32 v132, v132, s36, -v22
  v_fma_f32 v133, v133, s36, -v22
  v_fma_f32 v134, v134, s36, -v22
  v_fma_f32 v135, v135, s36, -v22
  v_exp_f32 v128, v128
  v_exp_f32 v129, v129
  v_exp_f32 v130, v130
  v_exp_f32 v131, v131
  v_exp_f32 v132, v132
  v_exp_f32 v133, v133
  v_exp_f32 v134, v134
  v_mfma_f32_32x32x16_bf16 v[64:79], a[12:15], a[204:207], v[64:79]
  buffer_load_dwordx4 v7, s[12:15], s83 offen offset:1024 lds
  v_exp_f32 v135, v135
  v_add_f32 v25, v128, v129
  v_cvt_pk_bf16_f32 v30, v128, v129
  v_add_f32 v25, v130, v25
  v_mfma_f32_32x32x16_bf16 v[64:79], a[16:19], a[208:211], v[64:79]
  v_add_f32 v25, v131, v25
  v_cvt_pk_bf16_f32 v31, v130, v131
  v_add_f32 v25, v132, v25
  v_add_f32 v25, v133, v25
  v_cvt_pk_bf16_f32 v32, v132, v133
  v_add_f32 v25, v134, v25
  v_add_f32 v25, v135, v25
  v_cvt_pk_bf16_f32 v33, v134, v135
  ds_write_b128 v15, v[30:33] offset:16384
  v_mfma_f32_32x32x16_bf16 v[64:79], a[20:23], a[212:215], v[64:79]
  v_fma_f32 v136, v136, s36, -v22
  buffer_load_dwordx4 v8, s[12:15], s83 offen offset:2048 lds
  v_fma_f32 v137, v137, s36, -v22
  v_fma_f32 v138, v138, s36, -v22
  v_fma_f32 v139, v139, s36, -v22
  v_fma_f32 v140, v140, s36, -v22
  v_mfma_f32_32x32x16_bf16 v[64:79], a[24:27], a[216:219], v[64:79]
  v_fma_f32 v141, v141, s36, -v22
  v_fma_f32 v142, v142, s36, -v22
  v_fma_f32 v143, v143, s36, -v22
  v_exp_f32 v136, v136
  v_exp_f32 v137, v137
  v_exp_f32 v138, v138
  v_exp_f32 v139, v139
  v_mfma_f32_32x32x16_bf16 v[64:79], a[28:31], a[220:223], v[64:79]
  v_exp_f32 v140, v140
  v_exp_f32 v141, v141
  v_exp_f32 v142, v142
  buffer_load_dwordx4 v9, s[12:15], s83 offen offset:3072 lds
  v_mfma_f32_32x32x16_bf16 v[80:95], a[32:35], a[192:195], 0
  s_nop 6
  v_max_f32 v62, v64, v65
  v_max3_f32 v62, v66, v67, v62
  v_max3_f32 v62, v68, v69, v62
  v_max3_f32 v62, v70, v71, v62
  v_max3_f32 v62, v72, v73, v62
  v_max3_f32 v62, v74, v75, v62
  v_max3_f32 v62, v76, v77, v62
  v_max3_f32 v62, v78, v79, v62
  v_exp_f32 v143, v143
  v_mfma_f32_32x32x16_bf16 v[80:95], a[36:39], a[196:199], v[80:95]
  v_add_f32 v25, v136, v25
  v_add_f32 v25, v137, v25
  v_cvt_pk_bf16_f32 v34, v136, v137
  v_add_f32 v25, v138, v25
  v_add_f32 v25, v139, v25
  v_cvt_pk_bf16_f32 v35, v138, v139
  v_add_f32 v25, v140, v25
  v_add_f32 v25, v141, v25
  v_cvt_pk_bf16_f32 v36, v140, v141
  v_add_f32 v25, v142, v25
  v_mfma_f32_32x32x16_bf16 v[80:95], a[40:43], a[200:203], v[80:95]
  v_add_f32 v25, v143, v25
  v_cvt_pk_bf16_f32 v37, v142, v143
  ds_write_b128 v15, v[34:37] offset:17408
  v_fma_f32 v144, v144, s36, -v22
  s_add_u32 m0, s76, 86016
  s_add_u32 s83, s79, 4096
  buffer_load_dwordx4 v6, s[12:15], s83 offen offset:0 lds
  v_mfma_f32_32x32x16_bf16 v[80:95], a[44:47], a[204:207], v[80:95]
  s_waitcnt vmcnt(9)
  v_fma_f32 v145, v145, s36, -v22
  v_fma_f32 v146, v146, s36, -v22
  v_fma_f32 v147, v147, s36, -v22
  v_fma_f32 v148, v148, s36, -v22
  v_fma_f32 v149, v149, s36, -v22
  v_fma_f32 v150, v150, s36, -v22
  v_xor_b32 v55, 0, v54
  ds_read_b128 a[64:67], v55
  v_fma_f32 v151, v151, s36, -v22
  v_mfma_f32_32x32x16_bf16 v[80:95], a[48:51], a[208:211], v[80:95]
  v_exp_f32 v144, v144
  v_exp_f32 v145, v145
  v_exp_f32 v146, v146
  v_exp_f32 v147, v147
  v_exp_f32 v148, v148
  v_xor_b32 v56, 32, v54
  ds_read_b128 a[68:71], v56
  v_mfma_f32_32x32x16_bf16 v[80:95], a[52:55], a[212:215], v[80:95]
  v_exp_f32 v149, v149
  buffer_load_dwordx4 v7, s[12:15], s83 offen offset:1024 lds
  v_exp_f32 v150, v150
  v_mfma_f32_32x32x16_bf16 v[80:95], a[56:59], a[216:219], v[80:95]
  v_exp_f32 v151, v151
  v_add_f32 v25, v144, v25
  v_add_f32 v25, v145, v25
  v_cvt_pk_bf16_f32 v38, v144, v145
  v_add_f32 v25, v146, v25
  v_xor_b32 v55, 64, v54
  ds_read_b128 a[72:75], v55
  v_add_f32 v25, v147, v25
  v_cvt_pk_bf16_f32 v39, v146, v147
  v_add_f32 v25, v148, v25
  v_mfma_f32_32x32x16_bf16 v[80:95], a[60:63], a[220:223], v[80:95]
  v_add_f32 v25, v149, v25
  v_cvt_pk_bf16_f32 v40, v148, v149
  v_add_f32 v25, v150, v25
  v_xor_b32 v56, 96, v54
  ds_read_b128 a[76:79], v56
  v_add_f32 v25, v151, v25
  v_cvt_pk_bf16_f32 v41, v150, v151
  ds_write_b128 v15, v[38:41] offset:24576
  buffer_load_dwordx4 v8, s[12:15], s83 offen offset:2048 lds
  v_fma_f32 v152, v152, s36, -v22
  v_fma_f32 v153, v153, s36, -v22
  v_fma_f32 v154, v154, s36, -v22
  v_fma_f32 v155, v155, s36, -v22
  v_xor_b32 v55, 128, v54
  ds_read_b128 a[80:83], v55
  v_fma_f32 v156, v156, s36, -v22
  v_fma_f32 v157, v157, s36, -v22
  v_fma_f32 v158, v158, s36, -v22
  v_fma_f32 v159, v159, s36, -v22
  v_exp_f32 v152, v152
  v_max3_f32 v62, v80, v81, v62
  v_exp_f32 v153, v153
  v_max3_f32 v62, v82, v83, v62
  v_xor_b32 v56, 160, v54
  ds_read_b128 a[84:87], v56
  v_max3_f32 v62, v84, v85, v62
  v_exp_f32 v154, v154
  v_max3_f32 v62, v86, v87, v62
  v_exp_f32 v155, v155
  v_max3_f32 v62, v88, v89, v62
  v_exp_f32 v156, v156
  v_max3_f32 v62, v90, v91, v62
  v_exp_f32 v157, v157
  v_max3_f32 v62, v92, v93, v62
  v_exp_f32 v158, v158
  v_max3_f32 v62, v94, v95, v62
  buffer_load_dwordx4 v9, s[12:15], s83 offen offset:3072 lds
  ds_write_b32 v60, v62 offset:2048
  v_exp_f32 v159, v159
  v_cvt_pk_bf16_f32 v42, v152, v153
  v_xor_b32 v55, 192, v54
  ds_read_b128 a[88:91], v55
  v_cvt_pk_bf16_f32 v43, v154, v155
  v_cvt_pk_bf16_f32 v44, v156, v157
  v_cvt_pk_bf16_f32 v45, v158, v159
  ds_write_b128 v15, v[42:45] offset:25600
  v_add_f32 v25, v152, v25
  v_add_f32 v25, v153, v25
  v_xor_b32 v56, 224, v54
  ds_read_b128 a[92:95], v56
  v_add_f32 v25, v154, v25
  v_add_f32 v25, v155, v25
  v_add_f32 v25, v156, v25
  v_add_f32 v25, v157, v25
  v_add_f32 v25, v158, v25
  v_add_f32 v25, v159, v25
  s_waitcnt lgkmcnt(0)
  s_barrier
  ds_read_b128 v[46:49], v61 offset:2048
  ds_read_b128 v[50:53], v61 offset:2064
  v_mfma_f32_32x32x16_bf16 v[128:143], a[64:67], a[128:131], 0
  v_mfma_f32_32x32x16_bf16 v[128:143], a[68:71], a[132:135], v[128:143]
  v_mfma_f32_32x32x16_bf16 v[128:143], a[72:75], a[136:139], v[128:143]
  s_lshr_b32 s4, s2, 3
  s_lshl_b32 s4, s4, 2
  s_add_u32 s4, s4, s3
  s_lshl_b32 s4, s4, 12
  s_lshl_b32 s5, s38, 19
  s_add_u32 s4, s4, s5
  v_lshlrev_b32 v5, 6, v1
  buffer_load_dword v5, v5, s[24:27], s4 offen
  s_waitcnt lgkmcnt(0)
  v_max3_f32 v46, v46, v47, v48
  v_max3_f32 v50, v50, v51, v52
  v_max3_f32 v46, v46, v49, v53
  v_max_f32 v46, v46, v50
  v_mul_f32 v23, s36, v46
  v_fma_f32 v64, v64, s36, -v23
  s_waitcnt vmcnt(1)
  v_fma_f32 v65, v65, s36, -v23
  v_fma_f32 v66, v66, s36, -v23
  v_fma_f32 v67, v67, s36, -v23
  v_fma_f32 v68, v68, s36, -v23
  v_fma_f32 v69, v69, s36, -v23
  v_fma_f32 v70, v70, s36, -v23
  v_xor_b32 v55, 0, v2
  ds_read_b128 a[96:99], v55
  v_fma_f32 v71, v71, s36, -v23
  v_exp_f32 v64, v64
  v_exp_f32 v65, v65
  v_exp_f32 v66, v66
  v_exp_f32 v67, v67
  v_exp_f32 v68, v68
  v_xor_b32 v56, 32, v2
  ds_read_b128 a[100:103], v56
  v_exp_f32 v69, v69
  v_exp_f32 v70, v70
  v_exp_f32 v71, v71
  v_mfma_f32_32x32x16_bf16 v[128:143], a[76:79], a[140:143], v[128:143]
  v_add_f32 v26, v64, v65
  v_cvt_pk_bf16_f32 v30, v64, v65
  v_add_f32 v26, v66, v26
  v_add_f32 v26, v67, v26
  v_xor_b32 v55, 64, v2
  ds_read_b128 a[104:107], v55
  v_cvt_pk_bf16_f32 v31, v66, v67
  v_add_f32 v26, v68, v26
  v_add_f32 v26, v69, v26
  v_cvt_pk_bf16_f32 v32, v68, v69
  v_add_f32 v26, v70, v26
  v_add_f32 v26, v71, v26
  v_mfma_f32_32x32x16_bf16 v[128:143], a[80:83], a[144:147], v[128:143]
  v_xor_b32 v56, 96, v2
  ds_read_b128 a[108:111], v56
  v_cvt_pk_bf16_f32 v33, v70, v71
  ds_write_b128 v15, v[30:33] offset:32768
  v_fma_f32 v72, v72, s36, -v23
  v_fma_f32 v73, v73, s36, -v23
  v_fma_f32 v74, v74, s36, -v23
  v_fma_f32 v75, v75, s36, -v23
  v_xor_b32 v55, 128, v2
  ds_read_b128 a[112:115], v55
  v_fma_f32 v76, v76, s36, -v23
  v_mfma_f32_32x32x16_bf16 v[128:143], a[84:87], a[148:151], v[128:143]
  v_fma_f32 v77, v77, s36, -v23
  v_fma_f32 v78, v78, s36, -v23
  v_fma_f32 v79, v79, s36, -v23
  v_exp_f32 v72, v72
  v_exp_f32 v73, v73
  v_exp_f32 v74, v74
  v_xor_b32 v56, 160, v2
  ds_read_b128 a[116:119], v56
  v_exp_f32 v75, v75
  v_mfma_f32_32x32x16_bf16 v[128:143], a[88:91], a[152:155], v[128:143]
  v_exp_f32 v76, v76
  v_exp_f32 v77, v77
  v_exp_f32 v78, v78
  v_exp_f32 v79, v79
  v_add_f32 v26, v72, v26
  v_xor_b32 v55, 192, v2
  ds_read_b128 a[120:123], v55
  v_add_f32 v26, v73, v26
  v_cvt_pk_bf16_f32 v34, v72, v73
  v_add_f32 v26, v74, v26
  v_mfma_f32_32x32x16_bf16 v[128:143], a[92:95], a[156:159], v[128:143]
  v_add_f32 v26, v75, v26
  v_cvt_pk_bf16_f32 v35, v74, v75
  v_add_f32 v26, v76, v26
  v_xor_b32 v56, 224, v2
  ds_read_b128 a[124:127], v56
  v_add_f32 v26, v77, v26
  v_cvt_pk_bf16_f32 v36, v76, v77
  v_add_f32 v26, v78, v26
  v_add_f32 v26, v79, v26
  v_cvt_pk_bf16_f32 v37, v78, v79
  ds_write_b128 v15, v[34:37] offset:33792
  s_waitcnt lgkmcnt(1)
  v_mfma_f32_32x32x16_bf16 v[144:159], a[96:99], a[128:131], 0
  v_max_f32 v62, v128, v129
  v_max3_f32 v62, v130, v131, v62
  v_max3_f32 v62, v132, v133, v62
  v_max3_f32 v62, v134, v135, v62
  v_max3_f32 v62, v136, v137, v62
  v_max3_f32 v62, v138, v139, v62
  v_max3_f32 v62, v140, v141, v62
  v_max3_f32 v62, v142, v143, v62
  v_fma_f32 v80, v80, s36, -v23
  v_mfma_f32_32x32x16_bf16 v[144:159], a[100:103], a[132:135], v[144:159]
  s_add_u32 m0, s76, 81920
  s_add_u32 s83, s65, 0
  buffer_load_dwordx4 v13, s[16:19], s83 offen offset:0 lds
  v_fma_f32 v81, v81, s36, -v23
  v_fma_f32 v82, v82, s36, -v23
  v_fma_f32 v83, v83, s36, -v23
  v_fma_f32 v84, v84, s36, -v23
  v_mfma_f32_32x32x16_bf16 v[144:159], a[104:107], a[136:139], v[144:159]
  v_fma_f32 v85, v85, s36, -v23
  v_fma_f32 v86, v86, s36, -v23
  v_fma_f32 v87, v87, s36, -v23
  buffer_load_dwordx4 v13, s[16:19], s83 offen offset:1024 lds
  v_mfma_f32_32x32x16_bf16 v[144:159], a[108:111], a[140:143], v[144:159]
  v_exp_f32 v80, v80
  v_exp_f32 v81, v81
  v_exp_f32 v82, v82
  v_exp_f32 v83, v83
  v_exp_f32 v84, v84
  v_mfma_f32_32x32x16_bf16 v[144:159], a[112:115], a[144:147], v[144:159]
  v_exp_f32 v85, v85
  v_exp_f32 v86, v86
  buffer_load_dwordx4 v13, s[16:19], s83 offen offset:2048 lds
  v_mfma_f32_32x32x16_bf16 v[144:159], a[116:119], a[148:151], v[144:159]
  v_exp_f32 v87, v87
  v_add_f32 v26, v80, v26
  v_add_f32 v26, v81, v26
  v_cvt_pk_bf16_f32 v38, v80, v81
  v_add_f32 v26, v82, v26
  v_add_f32 v26, v83, v26
  v_mfma_f32_32x32x16_bf16 v[144:159], a[120:123], a[152:155], v[144:159]
  v_cvt_pk_bf16_f32 v39, v82, v83
  buffer_load_dwordx4 v13, s[16:19], s83 offen offset:3072 lds
  v_add_f32 v26, v84, v26
  v_add_f32 v26, v85, v26
  v_cvt_pk_bf16_f32 v40, v84, v85
  v_mfma_f32_32x32x16_bf16 v[144:159], a[124:127], a[156:159], v[144:159]
  v_add_f32 v26, v86, v26
  v_add_f32 v26, v87, v26
  v_cvt_pk_bf16_f32 v41, v86, v87
  ds_write_b128 v15, v[38:41] offset:40960
  v_fma_f32 v88, v88, s36, -v23
  s_add_u32 m0, s76, 86016
  s_add_u32 s83, s65, 4096
  buffer_load_dwordx4 v13, s[16:19], s83 offen offset:0 lds
  v_fma_f32 v89, v89, s36, -v23
  v_fma_f32 v90, v90, s36, -v23
  v_fma_f32 v91, v91, s36, -v23
  v_fma_f32 v92, v92, s36, -v23
  v_fma_f32 v93, v93, s36, -v23
  v_fma_f32 v94, v94, s36, -v23
  v_fma_f32 v95, v95, s36, -v23
  buffer_load_dwordx4 v13, s[16:19], s83 offen offset:1024 lds
  v_exp_f32 v88, v88
  v_exp_f32 v89, v89
  v_max3_f32 v62, v144, v145, v62
  v_exp_f32 v90, v90
  v_max3_f32 v62, v146, v147, v62
  v_exp_f32 v91, v91
  v_max3_f32 v62, v148, v149, v62
  v_exp_f32 v92, v92
  v_max3_f32 v62, v150, v151, v62
  v_exp_f32 v93, v93
  v_max3_f32 v62, v152, v153, v62
  v_exp_f32 v94, v94
  v_max3_f32 v62, v154, v155, v62
  buffer_load_dwordx4 v13, s[16:19], s83 offen offset:2048 lds
  v_max3_f32 v62, v156, v157, v62
  v_exp_f32 v95, v95
  v_max3_f32 v62, v158, v159, v62
  v_cvt_pk_bf16_f32 v42, v88, v89
  ds_write_b32 v60, v62 offset:0
  v_cvt_pk_bf16_f32 v43, v90, v91
  v_cvt_pk_bf16_f32 v44, v92, v93
  v_cvt_pk_bf16_f32 v45, v94, v95
  ds_write_b128 v15, v[42:45] offset:41984
  v_add_f32 v26, v88, v26
  buffer_load_dwordx4 v13, s[16:19], s83 offen offset:3072 lds
  v_add_f32 v26, v89, v26
  v_add_f32 v26, v90, v26
  v_add_f32 v26, v91, v26
  v_add_f32 v26, v92, v26
  v_add_f32 v26, v93, v26
  v_add_f32 v26, v94, v26
  v_add_f32 v26, v95, v26
  s_waitcnt lgkmcnt(0)
  s_barrier
  ds_read_b128 v[46:49], v61 offset:0
  ds_read_b128 v[50:53], v61 offset:16
  ds_read_b64_tr_b16 v[96:97], v14 offset:0
  ds_read_b64_tr_b16 v[98:99], v14 offset:2048
  ds_read_b128 v[100:103], v11 offset:0
  ds_read_b128 v[104:107], v11 offset:16384
  ds_read_b128 v[108:111], v11 offset:32768
  ds_read_b64_tr_b16 v[112:113], v14 offset:4096
  ds_read_b64_tr_b16 v[114:115], v14 offset:6144
  ds_read_b128 v[116:119], v11 offset:1024
  ds_read_b128 v[120:123], v11 offset:17408
  ds_read_b128 v[124:127], v11 offset:33792
  v_mfma_f32_32x32x16_bf16 v[64:79], a[64:67], a[160:163], 0
  v_mfma_f32_32x32x16_bf16 v[64:79], a[68:71], a[164:167], v[64:79]
  v_mfma_f32_32x32x16_bf16 v[64:79], a[72:75], a[168:171], v[64:79]
  s_waitcnt lgkmcnt(10)
  v_max3_f32 v46, v46, v47, v48
  v_max3_f32 v50, v50, v51, v52
  v_max3_f32 v46, v46, v49, v53
  v_max_f32 v46, v46, v50
  v_mul_f32 v46, s36, v46
  v_max_f32 v46, v46, v21
  v_sub_f32 v47, v21, v46
  v_exp_f32 v57, v47
  v_mov_b32 v21, v46
  v_mul_f32 v24, v24, v57
  v_fma_f32 v128, v128, s36, -v21
  v_fma_f32 v129, v129, s36, -v21
  v_fma_f32 v130, v130, s36, -v21
  v_fma_f32 v131, v131, s36, -v21
  v_fma_f32 v132, v132, s36, -v21
  v_fma_f32 v133, v133, s36, -v21
  v_fma_f32 v134, v134, s36, -v21
  v_fma_f32 v135, v135, s36, -v21
  v_exp_f32 v128, v128
  v_exp_f32 v129, v129
  v_exp_f32 v130, v130
  s_waitcnt lgkmcnt(5)
  v_mfma_f32_32x32x16_bf16 a[0:15], v[96:99], v[100:103], 0
  ds_read_b64_tr_b16 v[160:161], v14 offset:8192
  v_exp_f32 v131, v131
  v_exp_f32 v132, v132
  v_exp_f32 v133, v133
  v_mfma_f32_32x32x16_bf16 a[16:31], v[96:99], v[104:107], 0
  ds_read_b64_tr_b16 v[162:163], v14 offset:10240
  ds_read_b128 v[164:167], v11 offset:2048
  v_exp_f32 v134, v134
  v_exp_f32 v135, v135
  v_add_f32 v24, v128, v24
  v_add_f32 v24, v129, v24
  v_mfma_f32_32x32x16_bf16 v[64:79], a[76:79], a[172:175], v[64:79]
  v_cvt_pk_bf16_f32 v30, v128, v129
  v_add_f32 v24, v130, v24
  v_add_f32 v24, v131, v24
  v_cvt_pk_bf16_f32 v31, v130, v131
  v_add_f32 v24, v132, v24
  v_add_f32 v24, v133, v24
  v_cvt_pk_bf16_f32 v32, v132, v133
  v_add_f32 v24, v134, v24
  v_mfma_f32_32x32x16_bf16 a[32:47], v[96:99], v[108:111], 0
  ds_read_b128 v[168:171], v11 offset:18432
  ds_read_b128 v[172:175], v11 offset:34816
  v_add_f32 v24, v135, v24
  v_cvt_pk_bf16_f32 v33, v134, v135
  ds_write_b128 v15, v[30:33] offset:49152
  v_fma_f32 v136, v136, s36, -v21
  v_mfma_f32_32x32x16_bf16 v[64:79], a[80:83], a[176:179], v[64:79]
  v_fma_f32 v137, v137, s36, -v21
  v_fma_f32 v138, v138, s36, -v21
  v_fma_f32 v139, v139, s36, -v21
  v_fma_f32 v140, v140, s36, -v21
  v_fma_f32 v141, v141, s36, -v21
  v_fma_f32 v142, v142, s36, -v21
  v_fma_f32 v143, v143, s36, -v21
  s_waitcnt lgkmcnt(6)
  v_mfma_f32_32x32x16_bf16 a[0:15], v[112:115], v[116:119], a[0:15]
  ds_read_b64_tr_b16 v[176:177], v14 offset:12288
  v_exp_f32 v136, v136
  v_exp_f32 v137, v137
  v_exp_f32 v138, v138
  v_exp_f32 v139, v139
  v_mfma_f32_32x32x16_bf16 v[64:79], a[84:87], a[180:183], v[64:79]
  v_exp_f32 v140, v140
  v_exp_f32 v141, v141
  v_exp_f32 v142, v142
  v_exp_f32 v143, v143
  v_mfma_f32_32x32x16_bf16 a[16:31], v[112:115], v[120:123], a[16:31]
  ds_read_b64_tr_b16 v[178:179], v14 offset:14336
  ds_read_b128 v[180:183], v11 offset:3072
  v_add_f32 v24, v136, v24
  v_add_f32 v24, v137, v24
  v_cvt_pk_bf16_f32 v34, v136, v137
  v_add_f32 v24, v138, v24
  v_add_f32 v24, v139, v24
  v_cvt_pk_bf16_f32 v35, v138, v139
  v_mfma_f32_32x32x16_bf16 v[64:79], a[88:91], a[184:187], v[64:79]
  v_add_f32 v24, v140, v24
  v_add_f32 v24, v141, v24
  v_cvt_pk_bf16_f32 v36, v140, v141
  v_add_f32 v24, v142, v24
  v_add_f32 v24, v143, v24
  v_cvt_pk_bf16_f32 v37, v142, v143
  v_mfma_f32_32x32x16_bf16 a[32:47], v[112:115], v[124:127], a[32:47]
  ds_read_b128 v[184:187], v11 offset:19456
  ds_read_b128 v[188:191], v11 offset:35840
  ds_write_b128 v15, v[34:37] offset:50176
  v_fma_f32 v144, v144, s36, -v21
  s_lshl_b32 s4, s39, 17
  s_lshl_b32 s5, s3, 8
  s_add_u32 s56, s4, s5
  v_lshrrev_b32 v3, 4, v1
  v_and_b32 v4, 15, v1
  v_lshlrev_b32 v4, 4, v4
  v_lshl_add_u32 v3, v3, 13, v4
  v_mfma_f32_32x32x16_bf16 v[64:79], a[92:95], a[188:191], v[64:79]
  v_fma_f32 v145, v145, s36, -v21
  v_fma_f32 v146, v146, s36, -v21
  s_add_u32 s62, s56, 32768
  buffer_load_dwordx4 a[224:227], v3, s[24:27], s62 offen offset:0
  s_waitcnt lgkmcnt(7)
  v_mfma_f32_32x32x16_bf16 a[0:15], v[160:163], v[164:167], a[0:15]
  ds_read_b64_tr_b16 v[96:97], v14 offset:16384
  s_nop 4
  v_max_f32 v62, v64, v65
  v_max3_f32 v62, v66, v67, v62
  v_max3_f32 v62, v68, v69, v62
  v_max3_f32 v62, v70, v71, v62
  v_max3_f32 v62, v72, v73, v62
  v_max3_f32 v62, v74, v75, v62
  v_mfma_f32_32x32x16_bf16 v[80:95], a[96:99], a[160:163], 0
  v_max3_f32 v62, v76, v77, v62
  v_max3_f32 v62, v78, v79, v62
  v_fma_f32 v147, v147, s36, -v21
  v_fma_f32 v148, v148, s36, -v21
  v_fma_f32 v149, v149, s36, -v21
  buffer_load_dwordx4 a[228:231], v3, s[24:27], s62 offen offset:1024
  v_mfma_f32_32x32x16_bf16 a[16:31], v[160:163], v[168:171], a[16:31]
  ds_read_b64_tr_b16 v[98:99], v14 offset:18432
  ds_read_b128 v[100:103], v11 offset:4096
  v_fma_f32 v150, v150, s36, -v21
  v_fma_f32 v151, v151, s36, -v21
  v_exp_f32 v144, v144
  v_mfma_f32_32x32x16_bf16 v[80:95], a[100:103], a[164:167], v[80:95]
  buffer_load_dwordx4 a[232:235], v3, s[24:27], s62 offen offset:2048
  v_exp_f32 v145, v145
  v_exp_f32 v146, v146
  v_mfma_f32_32x32x16_bf16 a[32:47], v[160:163], v[172:175], a[32:47]
  ds_read_b128 v[104:107], v11 offset:20480
  ds_read_b128 v[108:111], v11 offset:36864
  v_exp_f32 v147, v147
  buffer_load_dwordx4 a[236:239], v3, s[24:27], s62 offen offset:3072
  s_waitcnt lgkmcnt(6)
  v_mfma_f32_32x32x16_bf16 a[0:15], v[176:179], v[180:183], a[0:15]
  ds_read_b64_tr_b16 v[112:113], v14 offset:20480
  v_exp_f32 v148, v148
  v_exp_f32 v149, v149
  v_mfma_f32_32x32x16_bf16 v[80:95], a[104:107], a[168:171], v[80:95]
  s_add_u32 s62, s56, 36864
  buffer_load_dwordx4 a[240:243], v3, s[24:27], s62 offen offset:0
  v_exp_f32 v150, v150
  v_exp_f32 v151, v151
  v_mfma_f32_32x32x16_bf16 a[16:31], v[176:179], v[184:187], a[16:31]
  ds_read_b64_tr_b16 v[114:115], v14 offset:22528
  ds_read_b128 v[116:119], v11 offset:5120
  v_add_f32 v24, v144, v24
  buffer_load_dwordx4 a[244:247], v3, s[24:27], s62 offen offset:1024
  v_mfma_f32_32x32x16_bf16 v[80:95], a[108:111], a[172:175], v[80:95]
  v_add_f32 v24, v145, v24
  v_cvt_pk_bf16_f32 v38, v144, v145
  v_add_f32 v24, v146, v24
  buffer_load_dwordx4 a[248:251], v3, s[24:27], s62 offen offset:2048
  v_mfma_f32_32x32x16_bf16 a[32:47], v[176:179], v[188:191], a[32:47]
  ds_read_b128 v[120:123], v11 offset:21504
  ds_read_b128 v[124:127], v11 offset:37888
  v_add_f32 v24, v147, v24
  v_cvt_pk_bf16_f32 v39, v146, v147
  v_add_f32 v24, v148, v24
  buffer_load_dwordx4 a[252:255], v3, s[24:27], s62 offen offset:3072
  v_mfma_f32_32x32x16_bf16 v[80:95], a[112:115], a[176:179], v[80:95]
  v_add_f32 v24, v149, v24
  v_cvt_pk_bf16_f32 v40, v148, v149
  s_add_u32 s62, s56, 196608
  buffer_load_dwordx4 a[48:51], v3, s[24:27], s62 offen offset:0
  s_waitcnt lgkmcnt(5)
  v_mfma_f32_32x32x16_bf16 a[0:15], v[96:99], v[100:103], a[0:15]
  ds_read_b64_tr_b16 v[160:161], v14 offset:24576
  v_add_f32 v24, v150, v24
  v_add_f32 v24, v151, v24
  v_cvt_pk_bf16_f32 v41, v150, v151
  buffer_load_dwordx4 a[52:55], v3, s[24:27], s62 offen offset:1024
  v_mfma_f32_32x32x16_bf16 v[80:95], a[116:119], a[180:183], v[80:95]
  ds_write_b128 v15, v[38:41] offset:57344
  v_fma_f32 v152, v152, s36, -v21
  v_fma_f32 v153, v153, s36, -v21
  v_mfma_f32_32x32x16_bf16 a[16:31], v[96:99], v[104:107], a[16:31]
  ds_read_b64_tr_b16 v[162:163], v14 offset:26624
  ds_read_b128 v[164:167], v11 offset:6144
  buffer_load_dwordx4 a[56:59], v3, s[24:27], s62 offen offset:2048
  v_fma_f32 v154, v154, s36, -v21
  v_fma_f32 v155, v155, s36, -v21
  v_mfma_f32_32x32x16_bf16 v[80:95], a[120:123], a[184:187], v[80:95]
  v_fma_f32 v156, v156, s36, -v21
  buffer_load_dwordx4 a[60:63], v3, s[24:27], s62 offen offset:3072
  v_fma_f32 v157, v157, s36, -v21
  v_fma_f32 v158, v158, s36, -v21
  v_mfma_f32_32x32x16_bf16 a[32:47], v[96:99], v[108:111], a[32:47]
  ds_read_b128 v[168:171], v11 offset:22528
  ds_read_b128 v[172:175], v11 offset:38912
  s_add_u32 s62, s56, 0
  buffer_load_dwordx4 v[192:195], v3, s[24:27], s62 offen offset:0
  v_fma_f32 v159, v159, s36, -v21
  v_mfma_f32_32x32x16_bf16 v[80:95], a[124:127], a[188:191], v[80:95]
  v_exp_f32 v152, v152
  v_exp_f32 v153, v153
  buffer_load_dwordx4 v[196:199], v3, s[24:27], s62 offen offset:1024
  s_waitcnt lgkmcnt(6)
  v_mfma_f32_32x32x16_bf16 a[0:15], v[112:115], v[116:119], a[0:15]
  ds_read_b64_tr_b16 v[176:177], v14 offset:28672
  s_nop 5
  v_max3_f32 v62, v80, v81, v62
  v_max3_f32 v62, v82, v83, v62
  v_max3_f32 v62, v84, v85, v62
  v_max3_f32 v62, v86, v87, v62
  v_max3_f32 v62, v88, v89, v62
  v_max3_f32 v62, v90, v91, v62
  v_mfma_f32_32x32x16_bf16 a[16:31], v[112:115], v[120:123], a[16:31]
  ds_read_b64_tr_b16 v[178:179], v14 offset:30720
  ds_read_b128 v[180:183], v11 offset:7168
  v_max3_f32 v62, v92, v93, v62
  v_max3_f32 v62, v94, v95, v62
  ds_write_b32 v60, v62 offset:1024
  v_exp_f32 v154, v154
  v_exp_f32 v155, v155
  v_mfma_f32_32x32x16_bf16 a[32:47], v[112:115], v[124:127], a[32:47]
  ds_read_b128 v[184:187], v11 offset:23552
  ds_read_b128 v[188:191], v11 offset:39936
  v_exp_f32 v156, v156
  buffer_load_dwordx4 v[200:203], v3, s[24:27], s62 offen offset:2048
  s_waitcnt lgkmcnt(6)
  v_mfma_f32_32x32x16_bf16 a[0:15], v[160:163], v[164:167], a[0:15]
  v_exp_f32 v157, v157
  v_exp_f32 v158, v158
  v_exp_f32 v159, v159
  v_mfma_f32_32x32x16_bf16 a[16:31], v[160:163], v[168:171], a[16:31]
  buffer_load_dwordx4 v[204:207], v3, s[24:27], s62 offen offset:3072
  v_cvt_pk_bf16_f32 v42, v152, v153
  v_cvt_pk_bf16_f32 v43, v154, v155
  v_mfma_f32_32x32x16_bf16 a[32:47], v[160:163], v[172:175], a[32:47]
  s_add_u32 s62, s56, 4096
  buffer_load_dwordx4 v[208:211], v3, s[24:27], s62 offen offset:0
  v_cvt_pk_bf16_f32 v44, v156, v157
  v_cvt_pk_bf16_f32 v45, v158, v159
  ds_write_b128 v15, v[42:45] offset:58368
  s_waitcnt lgkmcnt(1)
  v_mfma_f32_32x32x16_bf16 a[0:15], v[176:179], v[180:183], a[0:15]
  buffer_load_dwordx4 v[212:215], v3, s[24:27], s62 offen offset:1024
  v_add_f32 v24, v152, v24
  v_add_f32 v24, v153, v24
  v_mfma_f32_32x32x16_bf16 a[16:31], v[176:179], v[184:187], a[16:31]
  v_add_f32 v24, v154, v24
  buffer_load_dwordx4 v[216:219], v3, s[24:27], s62 offen offset:2048
  v_add_f32 v24, v155, v24
  v_add_f32 v24, v156, v24
  v_mfma_f32_32x32x16_bf16 a[32:47], v[176:179], v[188:191], a[32:47]
  v_add_f32 v24, v157, v24
  buffer_load_dwordx4 v[220:223], v3, s[24:27], s62 offen offset:3072
  v_add_f32 v24, v158, v24
  v_add_f32 v24, v159, v24
  s_waitcnt vmcnt(20)
  s_waitcnt lgkmcnt(0)
  s_barrier
  ds_read_b128 v[46:49], v61 offset:1024
  ds_read_b128 v[50:53], v61 offset:1040
  ds_read_b64_tr_b16 v[96:97], v10 offset:0
  ds_read_b64_tr_b16 v[98:99], v10 offset:2048
  ds_read_b128 v[100:103], v11 offset:8192
  ds_read_b128 v[104:107], v11 offset:24576
  ds_read_b128 v[108:111], v11 offset:40960
  ds_read_b64_tr_b16 v[112:113], v10 offset:4096
  ds_read_b64_tr_b16 v[114:115], v10 offset:6144
  ds_read_b128 v[116:119], v11 offset:9216
  ds_read_b128 v[120:123], v11 offset:25600
  ds_read_b128 v[124:127], v11 offset:41984
  v_mfma_f32_32x32x16_bf16 v[128:143], a[64:67], a[192:195], 0
  v_mfma_f32_32x32x16_bf16 v[128:143], a[68:71], a[196:199], v[128:143]
  v_mfma_f32_32x32x16_bf16 v[128:143], a[72:75], a[200:203], v[128:143]
  s_waitcnt lgkmcnt(10)
  v_max3_f32 v46, v46, v47, v48
  v_max3_f32 v50, v50, v51, v52
  v_max3_f32 v46, v46, v49, v53
  v_max_f32 v46, v46, v50
  v_mul_f32 v46, s36, v46
  v_max_f32 v46, v46, v22
  v_sub_f32 v47, v22, v46
  v_exp_f32 v58, v47
  v_mov_b32 v22, v46
  v_mul_f32 v25, v25, v58
  v_fma_f32 v64, v64, s36, -v22
  s_add_u32 m0, s76, 49152
  s_add_u32 s83, s66, 0
  buffer_load_dwordx4 v13, s[16:19], s83 offen offset:0 lds
  v_fma_f32 v65, v65, s36, -v22
  v_fma_f32 v66, v66, s36, -v22
  v_fma_f32 v67, v67, s36, -v22
  v_fma_f32 v68, v68, s36, -v22
  v_fma_f32 v69, v69, s36, -v22
  s_waitcnt lgkmcnt(5)
  v_mfma_f32_32x32x16_bf16 a[0:15], v[96:99], v[100:103], a[0:15]
  ds_read_b64_tr_b16 v[160:161], v10 offset:8192
  v_fma_f32 v70, v70, s36, -v22
  v_fma_f32 v71, v71, s36, -v22
  buffer_load_dwordx4 v13, s[16:19], s83 offen offset:1024 lds
  v_mfma_f32_32x32x16_bf16 a[16:31], v[96:99], v[104:107], a[16:31]
  ds_read_b64_tr_b16 v[162:163], v10 offset:10240
  ds_read_b128 v[164:167], v11 offset:10240
  v_exp_f32 v64, v64
  v_exp_f32 v65, v65
  v_exp_f32 v66, v66
  v_mfma_f32_32x32x16_bf16 v[128:143], a[76:79], a[204:207], v[128:143]
  v_exp_f32 v67, v67
  v_exp_f32 v68, v68
  v_exp_f32 v69, v69
  v_mfma_f32_32x32x16_bf16 a[32:47], v[96:99], v[108:111], a[32:47]
  ds_read_b128 v[168:171], v11 offset:26624
  ds_read_b128 v[172:175], v11 offset:43008
  v_exp_f32 v70, v70
  buffer_load_dwordx4 v13, s[16:19], s83 offen offset:2048 lds
  v_mfma_f32_32x32x16_bf16 v[128:143], a[80:83], a[208:211], v[128:143]
  v_exp_f32 v71, v71
  v_add_f32 v25, v64, v25
  v_add_f32 v25, v65, v25
  v_cvt_pk_bf16_f32 v30, v64, v65
  v_add_f32 v25, v66, v25
  v_add_f32 v25, v67, v25
  s_waitcnt lgkmcnt(5)
  v_mfma_f32_32x32x16_bf16 a[0:15], v[112:115], v[116:119], a[0:15]
  ds_read_b64_tr_b16 v[176:177], v10 offset:12288
  v_cvt_pk_bf16_f32 v31, v66, v67
  buffer_load_dwordx4 v13, s[16:19], s83 offen offset:3072 lds
  v_mfma_f32_32x32x16_bf16 v[128:143], a[84:87], a[212:215], v[128:143]
  v_add_f32 v25, v68, v25
  v_add_f32 v25, v69, v25
  v_cvt_pk_bf16_f32 v32, v68, v69
  v_add_f32 v25, v70, v25
  v_add_f32 v25, v71, v25
  v_cvt_pk_bf16_f32 v33, v70, v71
  v_mfma_f32_32x32x16_bf16 a[16:31], v[112:115], v[120:123], a[16:31]
  ds_read_b64_tr_b16 v[178:179], v10 offset:14336
  ds_read_b128 v[180:183], v11 offset:11264
  ds_write_b128 v15, v[30:33] offset:0
  v_fma_f32 v72, v72, s36, -v22
  v_mfma_f32_32x32x16_bf16 v[128:143], a[88:91], a[216:219], v[128:143]
  s_add_u32 m0, s76, 53248
  s_add_u32 s83, s66, 4096
  buffer_load_dwordx4 v13, s[16:19], s83 offen offset:0 lds
  v_fma_f32 v73, v73, s36, -v22
  v_fma_f32 v74, v74, s36, -v22
  v_fma_f32 v75, v75, s36, -v22
  v_fma_f32 v76, v76, s36, -v22
  v_mfma_f32_32x32x16_bf16 a[32:47], v[112:115], v[124:127], a[32:47]
  ds_read_b128 v[184:187], v11 offset:27648
  ds_read_b128 v[188:191], v11 offset:44032
  v_fma_f32 v77, v77, s36, -v22
  v_fma_f32 v78, v78, s36, -v22
  v_fma_f32 v79, v79, s36, -v22
  buffer_load_dwordx4 v13, s[16:19], s83 offen offset:1024 lds
  v_mfma_f32_32x32x16_bf16 v[128:143], a[92:95], a[220:223], v[128:143]
  v_exp_f32 v72, v72
  v_exp_f32 v73, v73
  v_exp_f32 v74, v74
  s_waitcnt lgkmcnt(6)
  v_mfma_f32_32x32x16_bf16 a[0:15], v[160:163], v[164:167], a[0:15]
  ds_read_b64_tr_b16 v[96:97], v10 offset:16384
  s_nop 5
  v_max_f32 v62, v128, v129
  v_max3_f32 v62, v130, v131, v62
  v_max3_f32 v62, v132, v133, v62
  v_max3_f32 v62, v134, v135, v62
  v_max3_f32 v62, v136, v137, v62
  v_max3_f32 v62, v138, v139, v62
  v_mfma_f32_32x32x16_bf16 v[144:159], a[96:99], a[192:195], 0
  v_max3_f32 v62, v140, v141, v62
  v_max3_f32 v62, v142, v143, v62
  v_exp_f32 v75, v75
  v_exp_f32 v76, v76
  v_exp_f32 v77, v77
  v_mfma_f32_32x32x16_bf16 a[16:31], v[160:163], v[168:171], a[16:31]
  ds_read_b64_tr_b16 v[98:99], v10 offset:18432
  ds_read_b128 v[100:103], v11 offset:12288
  v_exp_f32 v78, v78
  buffer_load_dwordx4 v13, s[16:19], s83 offen offset:2048 lds
  v_mfma_f32_32x32x16_bf16 v[144:159], a[100:103], a[196:199], v[144:159]
  v_exp_f32 v79, v79
  v_add_f32 v25, v72, v25
  v_add_f32 v25, v73, v25
  v_cvt_pk_bf16_f32 v34, v72, v73
  v_mfma_f32_32x32x16_bf16 a[32:47], v[160:163], v[172:175], a[32:47]
  ds_read_b128 v[104:107], v11 offset:28672
  ds_read_b128 v[108:111], v11 offset:45056
  v_add_f32 v25, v74, v25
  v_add_f32 v25, v75, v25
  v_cvt_pk_bf16_f32 v35, v74, v75
  s_waitcnt lgkmcnt(5)
  v_mfma_f32_32x32x16_bf16 a[0:15], v[176:179], v[180:183], a[0:15]
  ds_read_b64_tr_b16 v[112:113], v10 offset:20480
  buffer_load_dwordx4 v13, s[16:19], s83 offen offset:3072 lds
  v_add_f32 v25, v76, v25
  v_add_f32 v25, v77, v25
  v_cvt_pk_bf16_f32 v36, v76, v77
  v_add_f32 v25, v78, v25
  v_mfma_f32_32x32x16_bf16 v[144:159], a[104:107], a[200:203], v[144:159]
  v_add_f32 v25, v79, v25
  v_cvt_pk_bf16_f32 v37, v78, v79
  ds_write_b128 v15, v[34:37] offset:1024
  v_fma_f32 v80, v80, s36, -v22
  v_mfma_f32_32x32x16_bf16 a[16:31], v[176:179], v[184:187], a[16:31]
  ds_read_b64_tr_b16 v[114:115], v10 offset:22528
  ds_read_b128 v[116:119], v11 offset:13312
  s_add_u32 s62, s56, 163840
  buffer_load_dwordx4 v[224:227], v3, s[24:27], s62 offen offset:0
  v_fma_f32 v81, v81, s36, -v22
  v_mfma_f32_32x32x16_bf16 v[144:159], a[108:111], a[204:207], v[144:159]
  v_fma_f32 v82, v82, s36, -v22
  v_fma_f32 v83, v83, s36, -v22
  v_fma_f32 v84, v84, s36, -v22
  v_fma_f32 v85, v85, s36, -v22
  v_fma_f32 v86, v86, s36, -v22
  v_fma_f32 v87, v87, s36, -v22
  v_mfma_f32_32x32x16_bf16 a[32:47], v[176:179], v[188:191], a[32:47]
  ds_read_b128 v[120:123], v11 offset:29696
  ds_read_b128 v[124:127], v11 offset:46080
  buffer_load_dwordx4 v[228:231], v3, s[24:27], s62 offen offset:1024
  v_exp_f32 v80, v80
  v_mfma_f32_32x32x16_bf16 v[144:159], a[112:115], a[208:211], v[144:159]
  v_exp_f32 v81, v81
  v_exp_f32 v82, v82
  v_exp_f32 v83, v83
  v_exp_f32 v84, v84
  s_waitcnt lgkmcnt(6)
  v_mfma_f32_32x32x16_bf16 a[0:15], v[96:99], v[100:103], a[0:15]
  ds_read_b64_tr_b16 v[160:161], v10 offset:24576
  v_exp_f32 v85, v85
  v_exp_f32 v86, v86
  v_mfma_f32_32x32x16_bf16 v[144:159], a[116:119], a[212:215], v[144:159]
  buffer_load_dwordx4 v[232:235], v3, s[24:27], s62 offen offset:2048
  v_exp_f32 v87, v87
  v_add_f32 v25, v80, v25
  v_add_f32 v25, v81, v25
  v_mfma_f32_32x32x16_bf16 a[16:31], v[96:99], v[104:107], a[16:31]
  ds_read_b64_tr_b16 v[162:163], v10 offset:26624
  ds_read_b128 v[164:167], v11 offset:14336
  v_cvt_pk_bf16_f32 v38, v80, v81
  v_add_f32 v25, v82, v25
  v_add_f32 v25, v83, v25
  v_cvt_pk_bf16_f32 v39, v82, v83
  v_mfma_f32_32x32x16_bf16 v[144:159], a[120:123], a[216:219], v[144:159]
  buffer_load_dwordx4 v[236:239], v3, s[24:27], s62 offen offset:3072
  v_add_f32 v25, v84, v25
  v_add_f32 v25, v85, v25
  v_cvt_pk_bf16_f32 v40, v84, v85
  v_add_f32 v25, v86, v25
  v_mfma_f32_32x32x16_bf16 a[32:47], v[96:99], v[108:111], a[32:47]
  ds_read_b128 v[168:171], v11 offset:30720
  ds_read_b128 v[172:175], v11 offset:47104
  v_add_f32 v25, v87, v25
  v_cvt_pk_bf16_f32 v41, v86, v87
  ds_write_b128 v15, v[38:41] offset:16384
  v_mfma_f32_32x32x16_bf16 v[144:159], a[124:127], a[220:223], v[144:159]
  v_fma_f32 v88, v88, s36, -v22
  s_add_u32 s62, s56, 167936
  buffer_load_dwordx4 v[240:243], v3, s[24:27], s62 offen offset:0
  v_fma_f32 v89, v89, s36, -v22
  s_waitcnt lgkmcnt(6)
  v_mfma_f32_32x32x16_bf16 a[0:15], v[112:115], v[116:119], a[0:15]
  ds_read_b64_tr_b16 v[176:177], v10 offset:28672
  s_nop 4
  v_max3_f32 v62, v144, v145, v62
  v_max3_f32 v62, v146, v147, v62
  v_max3_f32 v62, v148, v149, v62
  v_max3_f32 v62, v150, v151, v62
  v_max3_f32 v62, v152, v153, v62
  v_max3_f32 v62, v154, v155, v62
  v_mfma_f32_32x32x16_bf16 a[16:31], v[112:115], v[120:123], a[16:31]
  ds_read_b64_tr_b16 v[178:179], v10 offset:30720
  ds_read_b128 v[180:183], v11 offset:15360
  v_max3_f32 v62, v156, v157, v62
  v_max3_f32 v62, v158, v159, v62
  ds_write_b32 v60, v62 offset:2048
  v_fma_f32 v90, v90, s36, -v22
  v_fma_f32 v91, v91, s36, -v22
  v_fma_f32 v92, v92, s36, -v22
  v_mfma_f32_32x32x16_bf16 a[32:47], v[112:115], v[124:127], a[32:47]
  ds_read_b128 v[184:187], v11 offset:31744
  ds_read_b128 v[188:191], v11 offset:48128
  v_fma_f32 v93, v93, s36, -v22
  v_fma_f32 v94, v94, s36, -v22
  v_fma_f32 v95, v95, s36, -v22
  s_waitcnt lgkmcnt(7)
  v_mfma_f32_32x32x16_bf16 a[0:15], v[160:163], v[164:167], a[0:15]
  buffer_load_dwordx4 v[244:247], v3, s[24:27], s62 offen offset:1024
  v_exp_f32 v88, v88
  v_exp_f32 v89, v89
  v_mfma_f32_32x32x16_bf16 a[16:31], v[160:163], v[168:171], a[16:31]
  v_exp_f32 v90, v90
  v_exp_f32 v91, v91
  v_exp_f32 v92, v92
  v_exp_f32 v93, v93
  v_mfma_f32_32x32x16_bf16 a[32:47], v[160:163], v[172:175], a[32:47]
  v_exp_f32 v94, v94
  buffer_load_dwordx4 v[248:251], v3, s[24:27], s62 offen offset:2048
  s_waitcnt lgkmcnt(0)
  v_mfma_f32_32x32x16_bf16 a[0:15], v[176:179], v[180:183], a[0:15]
  v_exp_f32 v95, v95
  v_cvt_pk_bf16_f32 v42, v88, v89
  v_cvt_pk_bf16_f32 v43, v90, v91
  v_cvt_pk_bf16_f32 v44, v92, v93
  v_cvt_pk_bf16_f32 v45, v94, v95
  v_mfma_f32_32x32x16_bf16 a[16:31], v[176:179], v[184:187], a[16:31]
  ds_write_b128 v15, v[42:45] offset:17408
  v_add_f32 v25, v88, v25
  buffer_load_dwordx4 v[252:255], v3, s[24:27], s62 offen offset:3072
  v_mfma_f32_32x32x16_bf16 a[32:47], v[176:179], v[188:191], a[32:47]
  v_add_f32 v25, v89, v25
  v_add_f32 v25, v90, v25
  v_add_f32 v25, v91, v25
  v_add_f32 v25, v92, v25
  v_add_f32 v25, v93, v25
  v_add_f32 v25, v94, v25
  v_add_f32 v25, v95, v25
  s_waitcnt vmcnt(8)
  s_waitcnt lgkmcnt(0)
  s_barrier
  ds_read_b128 v[46:49], v61 offset:2048
  ds_read_b128 v[50:53], v61 offset:2064
  ds_read_b64_tr_b16 v[96:97], v14 offset:0
  ds_read_b64_tr_b16 v[98:99], v14 offset:2048
  ds_read_b128 v[100:103], v11 offset:49152
  ds_read_b128 v[104:107], v11 offset:0
  ds_read_b64_tr_b16 v[112:113], v14 offset:4096
  ds_read_b64_tr_b16 v[114:115], v14 offset:6144
  ds_read_b128 v[116:119], v11 offset:50176
  ds_read_b128 v[120:123], v11 offset:1024
  s_waitcnt lgkmcnt(8)
  s_add_u32 s62, s56, 65536
  buffer_load_dwordx4 a[128:131], v3, s[24:27], s62 offen offset:0
  v_max3_f32 v46, v46, v47, v48
  v_max3_f32 v50, v50, v51, v52
  v_max3_f32 v46, v46, v49, v53
  v_max_f32 v46, v46, v50
  v_mul_f32 v46, s36, v46
  v_max_f32 v46, v46, v23
  v_sub_f32 v47, v23, v46
  v_exp_f32 v59, v47
  v_mov_b32 v23, v46
  v_mul_f32 v26, v26, v59
  buffer_load_dwordx4 a[132:135], v3, s[24:27], s62 offen offset:1024
  ds_write_b32 v60, v24 offset:4096
  ds_write_b32 v60, v25 offset:5120
  v_fma_f32 v128, v128, s36, -v23
  s_add_u32 m0, s76, 81920
  s_add_u32 s83, s67, 0
  buffer_load_dwordx4 v13, s[16:19], s83 offen offset:0 lds
  s_waitcnt lgkmcnt(6)
  v_mfma_f32_32x32x16_bf16 a[64:79], v[96:99], v[100:103], 0
  ds_read_b64_tr_b16 v[160:161], v14 offset:8192
  ds_read_b64_tr_b16 v[162:163], v14 offset:10240
  v_fma_f32 v129, v129, s36, -v23
  v_fma_f32 v130, v130, s36, -v23
  v_fma_f32 v131, v131, s36, -v23
  v_fma_f32 v132, v132, s36, -v23
  buffer_load_dwordx4 v13, s[16:19], s83 offen offset:1024 lds
  v_fma_f32 v133, v133, s36, -v23
  v_fma_f32 v134, v134, s36, -v23
  buffer_load_dwordx4 a[136:139], v3, s[24:27], s62 offen offset:2048
  v_mfma_f32_32x32x16_bf16 a[80:95], v[96:99], v[104:107], 0
  ds_read_b128 v[164:167], v11 offset:51200
  ds_read_b128 v[168:171], v11 offset:2048
  v_fma_f32 v135, v135, s36, -v23
  v_exp_f32 v128, v128
  v_exp_f32 v129, v129
  buffer_load_dwordx4 v13, s[16:19], s83 offen offset:2048 lds
  v_exp_f32 v130, v130
  v_exp_f32 v131, v131
  v_exp_f32 v132, v132
  s_waitcnt lgkmcnt(6)
  v_mfma_f32_32x32x16_bf16 a[64:79], v[112:115], v[116:119], a[64:79]
  ds_read_b64_tr_b16 v[176:177], v14 offset:12288
  ds_read_b64_tr_b16 v[178:179], v14 offset:14336
  v_exp_f32 v133, v133
  v_exp_f32 v134, v134
  buffer_load_dwordx4 v13, s[16:19], s83 offen offset:3072 lds
  buffer_load_dwordx4 a[140:143], v3, s[24:27], s62 offen offset:3072
  v_exp_f32 v135, v135
  v_mfma_f32_32x32x16_bf16 a[80:95], v[112:115], v[120:123], a[80:95]
  ds_read_b128 v[180:183], v11 offset:52224
  ds_read_b128 v[184:187], v11 offset:3072
  v_add_f32 v26, v128, v26
  v_add_f32 v26, v129, v26
  v_cvt_pk_bf16_f32 v30, v128, v129
  v_add_f32 v26, v130, v26
  s_add_u32 m0, s76, 86016
  s_add_u32 s83, s67, 4096
  buffer_load_dwordx4 v13, s[16:19], s83 offen offset:0 lds
  v_add_f32 v26, v131, v26
  v_cvt_pk_bf16_f32 v31, v130, v131
  v_add_f32 v26, v132, v26
  v_add_f32 v26, v133, v26
  buffer_load_dwordx4 v13, s[16:19], s83 offen offset:1024 lds
  s_waitcnt lgkmcnt(4)
  v_mfma_f32_32x32x16_bf16 a[64:79], v[160:163], v[164:167], a[64:79]
  ds_read_b64_tr_b16 v[96:97], v14 offset:16384
  ds_read_b64_tr_b16 v[98:99], v14 offset:18432
  s_add_u32 s62, s56, 69632
  buffer_load_dwordx4 a[144:147], v3, s[24:27], s62 offen offset:0
  v_cvt_pk_bf16_f32 v32, v132, v133
  v_add_f32 v26, v134, v26
  v_add_f32 v26, v135, v26
  v_cvt_pk_bf16_f32 v33, v134, v135
  ds_write_b128 v15, v[30:33] offset:32768
  v_mfma_f32_32x32x16_bf16 a[80:95], v[160:163], v[168:171], a[80:95]
  ds_read_b128 v[100:103], v11 offset:53248
  ds_read_b128 v[104:107], v11 offset:4096
  buffer_load_dwordx4 v13, s[16:19], s83 offen offset:2048 lds
  v_fma_f32 v136, v136, s36, -v23
  v_fma_f32 v137, v137, s36, -v23
  v_fma_f32 v138, v138, s36, -v23
  v_fma_f32 v139, v139, s36, -v23
  buffer_load_dwordx4 a[148:151], v3, s[24:27], s62 offen offset:1024
  v_fma_f32 v140, v140, s36, -v23
  buffer_load_dwordx4 v13, s[16:19], s83 offen offset:3072 lds
  s_waitcnt lgkmcnt(5)
  v_mfma_f32_32x32x16_bf16 a[64:79], v[176:179], v[180:183], a[64:79]
  ds_read_b64_tr_b16 v[112:113], v14 offset:20480
  ds_read_b64_tr_b16 v[114:115], v14 offset:22528
  v_fma_f32 v141, v141, s36, -v23
  v_fma_f32 v142, v142, s36, -v23
  v_fma_f32 v143, v143, s36, -v23
  v_exp_f32 v136, v136
  v_exp_f32 v137, v137
  v_exp_f32 v138, v138
  v_exp_f32 v139, v139
  v_exp_f32 v140, v140
  v_mfma_f32_32x32x16_bf16 a[80:95], v[176:179], v[184:187], a[80:95]
  ds_read_b128 v[116:119], v11 offset:54272
  ds_read_b128 v[120:123], v11 offset:5120
  v_exp_f32 v141, v141
  buffer_load_dwordx4 a[152:155], v3, s[24:27], s62 offen offset:2048
  v_exp_f32 v142, v142
  v_exp_f32 v143, v143
  v_add_f32 v26, v136, v26
  v_add_f32 v26, v137, v26
  v_cvt_pk_bf16_f32 v34, v136, v137
  v_add_f32 v26, v138, v26
  v_add_f32 v26, v139, v26
  s_waitcnt lgkmcnt(4)
  v_mfma_f32_32x32x16_bf16 a[64:79], v[96:99], v[100:103], a[64:79]
  ds_read_b64_tr_b16 v[160:161], v14 offset:24576
  ds_read_b64_tr_b16 v[162:163], v14 offset:26624
  v_cvt_pk_bf16_f32 v35, v138, v139
  v_add_f32 v26, v140, v26
  v_add_f32 v26, v141, v26
  buffer_load_dwordx4 a[156:159], v3, s[24:27], s62 offen offset:3072
  v_cvt_pk_bf16_f32 v36, v140, v141
  v_add_f32 v26, v142, v26
  v_add_f32 v26, v143, v26
  v_cvt_pk_bf16_f32 v37, v142, v143
  ds_write_b128 v15, v[34:37] offset:33792
  v_fma_f32 v144, v144, s36, -v23
  v_mfma_f32_32x32x16_bf16 a[80:95], v[96:99], v[104:107], a[80:95]
  ds_read_b128 v[164:167], v11 offset:55296
  ds_read_b128 v[168:171], v11 offset:6144
  v_fma_f32 v145, v145, s36, -v23
  v_fma_f32 v146, v146, s36, -v23
  v_fma_f32 v147, v147, s36, -v23
  v_fma_f32 v148, v148, s36, -v23
  v_fma_f32 v149, v149, s36, -v23
  s_add_u32 s62, s56, 98304
  buffer_load_dwordx4 a[160:163], v3, s[24:27], s62 offen offset:0
  v_fma_f32 v150, v150, s36, -v23
  v_fma_f32 v151, v151, s36, -v23
  v_exp_f32 v144, v144
  v_exp_f32 v145, v145
  s_waitcnt lgkmcnt(5)
  v_mfma_f32_32x32x16_bf16 a[64:79], v[112:115], v[116:119], a[64:79]
  ds_read_b64_tr_b16 v[176:177], v14 offset:28672
  ds_read_b64_tr_b16 v[178:179], v14 offset:30720
  v_exp_f32 v146, v146
  v_exp_f32 v147, v147
  v_exp_f32 v148, v148
  v_exp_f32 v149, v149
  v_exp_f32 v150, v150
  v_exp_f32 v151, v151
  buffer_load_dwordx4 a[164:167], v3, s[24:27], s62 offen offset:1024
  v_mfma_f32_32x32x16_bf16 a[80:95], v[112:115], v[120:123], a[80:95]
  ds_read_b128 v[180:183], v11 offset:56320
  ds_read_b128 v[184:187], v11 offset:7168
  v_add_f32 v26, v144, v26
  v_add_f32 v26, v145, v26
  v_cvt_pk_bf16_f32 v38, v144, v145
  v_add_f32 v26, v146, v26
  v_add_f32 v26, v147, v26
  v_cvt_pk_bf16_f32 v39, v146, v147
  v_add_f32 v26, v148, v26
  v_add_f32 v26, v149, v26
  v_cvt_pk_bf16_f32 v40, v148, v149
  v_add_f32 v26, v150, v26
  v_add_f32 v26, v151, v26
  buffer_load_dwordx4 a[168:171], v3, s[24:27], s62 offen offset:2048
  s_waitcnt lgkmcnt(4)
  v_mfma_f32_32x32x16_bf16 a[64:79], v[160:163], v[164:167], a[64:79]
  v_cvt_pk_bf16_f32 v41, v150, v151
  ds_write_b128 v15, v[38:41] offset:8192
  v_fma_f32 v152, v152, s36, -v23
  v_fma_f32 v153, v153, s36, -v23
  v_fma_f32 v154, v154, s36, -v23
  v_fma_f32 v155, v155, s36, -v23
  v_fma_f32 v156, v156, s36, -v23
  v_fma_f32 v157, v157, s36, -v23
  v_fma_f32 v158, v158, s36, -v23
  v_fma_f32 v159, v159, s36, -v23
  buffer_load_dwordx4 a[172:175], v3, s[24:27], s62 offen offset:3072
  v_mfma_f32_32x32x16_bf16 a[80:95], v[160:163], v[168:171], a[80:95]
  v_exp_f32 v152, v152
  v_exp_f32 v153, v153
  v_exp_f32 v154, v154
  v_exp_f32 v155, v155
  v_exp_f32 v156, v156
  v_exp_f32 v157, v157
  v_exp_f32 v158, v158
  v_exp_f32 v159, v159
  v_cvt_pk_bf16_f32 v42, v152, v153
  s_waitcnt lgkmcnt(1)
  v_mfma_f32_32x32x16_bf16 a[64:79], v[176:179], v[180:183], a[64:79]
  v_cvt_pk_bf16_f32 v43, v154, v155
  v_cvt_pk_bf16_f32 v44, v156, v157
  s_add_u32 s62, s56, 102400
  buffer_load_dwordx4 a[176:179], v3, s[24:27], s62 offen offset:0
  v_cvt_pk_bf16_f32 v45, v158, v159
  ds_write_b128 v15, v[42:45] offset:9216
  v_add_f32 v26, v152, v26
  v_add_f32 v26, v153, v26
  v_add_f32 v26, v154, v26
  v_add_f32 v26, v155, v26
  v_add_f32 v26, v156, v26
  v_add_f32 v26, v157, v26
  v_mfma_f32_32x32x16_bf16 a[80:95], v[176:179], v[184:187], a[80:95]
  v_add_f32 v26, v158, v26
  v_add_f32 v26, v159, v26
  ds_write_b32 v60, v26 offset:6144
  buffer_load_dwordx4 a[180:183], v3, s[24:27], s62 offen offset:1024
  buffer_load_dwordx4 a[184:187], v3, s[24:27], s62 offen offset:2048
  buffer_load_dwordx4 a[188:191], v3, s[24:27], s62 offen offset:3072
  s_waitcnt vmcnt(10)
  s_waitcnt lgkmcnt(0)
  s_barrier
  s_mul_i32 s4, s37, 393216
  s_lshl_b32 s5, s39, 2
  s_add_u32 s5, s5, s3
  s_mul_i32 s5, s5, 3072
  s_add_u32 s57, s4, s5
  ds_read_b64_tr_b16 v[96:97], v14 offset:0
  ds_read_b64_tr_b16 v[98:99], v14 offset:2048
  ds_read_b128 v[108:111], v11 offset:32768
  ds_read_b64_tr_b16 v[112:113], v14 offset:4096
  ds_read_b64_tr_b16 v[114:115], v14 offset:6144
  ds_read_b128 v[124:127], v11 offset:33792
  ds_read_b128 v[46:49], v61 offset:4096
  ds_read_b128 v[50:53], v61 offset:4112
  s_waitcnt lgkmcnt(0)
  v_add_f32 v46, v46, v47
  v_add_f32 v48, v48, v49
  v_add_f32 v50, v50, v51
  v_add_f32 v52, v52, v53
  v_add_f32 v46, v46, v48
  v_add_f32 v50, v50, v52
  v_add_f32 v46, v46, v50
  v_rcp_f32 v24, v46
  s_nop 0
  v_mul_f32 v57, v57, v24
  s_add_u32 s62, s56, 131072
  buffer_load_dwordx4 a[192:195], v3, s[24:27], s62 offen offset:0
  v_mfma_f32_32x32x16_bf16 a[96:111], v[96:99], v[108:111], 0
  ds_read_b64_tr_b16 v[160:161], v14 offset:8192
  ds_read_b64_tr_b16 v[162:163], v14 offset:10240
  ds_read_b128 v[172:175], v11 offset:34816
  v_accvgpr_read_b32 v64, a0
  v_mul_f32 v64, v64, v57
  v_accvgpr_read_b32 v65, a1
  v_mul_f32 v65, v65, v57
  v_mfma_f32_32x32x16_bf16 a[96:111], v[112:115], v[124:127], a[96:111]
  ds_read_b64_tr_b16 v[176:177], v14 offset:12288
  ds_read_b64_tr_b16 v[178:179], v14 offset:14336
  ds_read_b128 v[188:191], v11 offset:35840
  buffer_load_dwordx4 a[196:199], v3, s[24:27], s62 offen offset:1024
  v_accvgpr_read_b32 v66, a2
  v_mul_f32 v66, v66, v57
  s_waitcnt lgkmcnt(3)
  v_mfma_f32_32x32x16_bf16 a[96:111], v[160:163], v[172:175], a[96:111]
  ds_read_b64_tr_b16 v[96:97], v14 offset:16384
  ds_read_b64_tr_b16 v[98:99], v14 offset:18432
  ds_read_b128 v[108:111], v11 offset:36864
  v_accvgpr_read_b32 v67, a3
  v_mul_f32 v67, v67, v57
  v_accvgpr_read_b32 v68, a4
  v_mul_f32 v68, v68, v57
  s_waitcnt lgkmcnt(3)
  v_mfma_f32_32x32x16_bf16 a[96:111], v[176:179], v[188:191], a[96:111]
  ds_read_b64_tr_b16 v[112:113], v14 offset:20480
  ds_read_b64_tr_b16 v[114:115], v14 offset:22528
  ds_read_b128 v[124:127], v11 offset:37888
  buffer_load_dwordx4 a[200:203], v3, s[24:27], s62 offen offset:2048
  v_accvgpr_read_b32 v69, a5
  v_mul_f32 v69, v69, v57
  s_waitcnt lgkmcnt(3)
  v_mfma_f32_32x32x16_bf16 a[96:111], v[96:99], v[108:111], a[96:111]
  ds_read_b64_tr_b16 v[160:161], v14 offset:24576
  ds_read_b64_tr_b16 v[162:163], v14 offset:26624
  ds_read_b128 v[172:175], v11 offset:38912
  v_accvgpr_read_b32 v70, a6
  v_mul_f32 v70, v70, v57
  buffer_load_dwordx4 a[204:207], v3, s[24:27], s62 offen offset:3072
  s_waitcnt lgkmcnt(3)
  v_mfma_f32_32x32x16_bf16 a[96:111], v[112:115], v[124:127], a[96:111]
  ds_read_b64_tr_b16 v[176:177], v14 offset:28672
  ds_read_b64_tr_b16 v[178:179], v14 offset:30720
  ds_read_b128 v[188:191], v11 offset:39936
  v_accvgpr_read_b32 v71, a7
  v_mul_f32 v71, v71, v57
  v_accvgpr_read_b32 v72, a8
  v_mul_f32 v72, v72, v57
  s_waitcnt lgkmcnt(3)
  v_mfma_f32_32x32x16_bf16 a[96:111], v[160:163], v[172:175], a[96:111]
  ds_read_b64_tr_b16 v[96:97], v10 offset:0
  ds_read_b64_tr_b16 v[98:99], v10 offset:2048
  ds_read_b128 v[100:103], v11 offset:57344
  ds_read_b128 v[104:107], v11 offset:16384
  ds_read_b128 v[108:111], v11 offset:8192
  v_accvgpr_read_b32 v73, a9
  v_mul_f32 v73, v73, v57
  s_waitcnt lgkmcnt(5)
  v_mfma_f32_32x32x16_bf16 a[96:111], v[176:179], v[188:191], a[96:111]
  ds_read_b64_tr_b16 v[112:113], v10 offset:4096
  ds_read_b64_tr_b16 v[114:115], v10 offset:6144
  ds_read_b128 v[116:119], v11 offset:58368
  ds_read_b128 v[120:123], v11 offset:17408
  ds_read_b128 v[124:127], v11 offset:9216
  s_add_u32 s62, s56, 135168
  buffer_load_dwordx4 a[208:211], v3, s[24:27], s62 offen offset:0
  s_waitcnt lgkmcnt(5)
  v_mfma_f32_32x32x16_bf16 a[64:79], v[96:99], v[100:103], a[64:79]
  ds_read_b64_tr_b16 v[160:161], v10 offset:8192
  v_accvgpr_read_b32 v74, a10
  v_mul_f32 v74, v74, v57
  v_accvgpr_read_b32 v75, a11
  v_mul_f32 v75, v75, v57
  buffer_load_dwordx4 a[212:215], v3, s[24:27], s62 offen offset:1024
  v_mfma_f32_32x32x16_bf16 a[80:95], v[96:99], v[104:107], a[80:95]
  ds_read_b64_tr_b16 v[162:163], v10 offset:10240
  ds_read_b128 v[164:167], v11 offset:59392
  v_accvgpr_read_b32 v76, a12
  v_mul_f32 v76, v76, v57
  v_accvgpr_read_b32 v77, a13
  v_mul_f32 v77, v77, v57
  v_accvgpr_read_b32 v78, a14
  v_mul_f32 v78, v78, v57
  v_mfma_f32_32x32x16_bf16 a[96:111], v[96:99], v[108:111], a[96:111]
  ds_read_b128 v[168:171], v11 offset:18432
  ds_read_b128 v[172:175], v11 offset:10240
  buffer_load_dwordx4 a[216:219], v3, s[24:27], s62 offen offset:2048
  s_waitcnt lgkmcnt(5)
  v_mfma_f32_32x32x16_bf16 a[64:79], v[112:115], v[116:119], a[64:79]
  ds_read_b64_tr_b16 v[176:177], v10 offset:12288
  v_accvgpr_read_b32 v79, a15
  v_mul_f32 v79, v79, v57
  ds_read_b128 v[46:49], v61 offset:5120
  ds_read_b128 v[50:53], v61 offset:5136
  s_waitcnt lgkmcnt(0)
  v_add_f32 v46, v46, v47
  v_add_f32 v48, v48, v49
  v_add_f32 v50, v50, v51
  v_add_f32 v52, v52, v53
  v_add_f32 v46, v46, v48
  v_add_f32 v50, v50, v52
  v_add_f32 v46, v46, v50
  v_rcp_f32 v25, v46
  s_nop 0
  v_mul_f32 v58, v58, v25
  v_mfma_f32_32x32x16_bf16 a[80:95], v[112:115], v[120:123], a[80:95]
  ds_read_b64_tr_b16 v[178:179], v10 offset:14336
  ds_read_b128 v[180:183], v11 offset:60416
  v_mfma_f32_32x32x16_bf16 a[96:111], v[112:115], v[124:127], a[96:111]
  ds_read_b128 v[184:187], v11 offset:19456
  ds_read_b128 v[188:191], v11 offset:11264
  buffer_load_dwordx4 a[220:223], v3, s[24:27], s62 offen offset:3072
  v_accvgpr_read_b32 v80, a16
  v_mul_f32 v80, v80, v58
  v_mfma_f32_32x32x16_bf16 a[64:79], v[160:163], v[164:167], a[64:79]
  ds_read_b64_tr_b16 v[96:97], v10 offset:16384
  v_accvgpr_read_b32 v81, a17
  v_mul_f32 v81, v81, v58
  v_accvgpr_read_b32 v82, a18
  v_mul_f32 v82, v82, v58
  s_add_u32 s62, s56, 200704
  buffer_load_dwordx4 a[112:115], v3, s[24:27], s62 offen offset:0
  v_mfma_f32_32x32x16_bf16 a[80:95], v[160:163], v[168:171], a[80:95]
  ds_read_b64_tr_b16 v[98:99], v10 offset:18432
  ds_read_b128 v[100:103], v11 offset:61440
  v_accvgpr_read_b32 v83, a19
  v_mul_f32 v83, v83, v58
  v_accvgpr_read_b32 v84, a20
  v_mul_f32 v84, v84, v58
  v_mfma_f32_32x32x16_bf16 a[96:111], v[160:163], v[172:175], a[96:111]
  ds_read_b128 v[104:107], v11 offset:20480
  ds_read_b128 v[108:111], v11 offset:12288
  buffer_load_dwordx4 a[116:119], v3, s[24:27], s62 offen offset:1024
  v_accvgpr_read_b32 v85, a21
  v_mul_f32 v85, v85, v58
  v_accvgpr_read_b32 v86, a22
  v_mul_f32 v86, v86, v58
  s_waitcnt lgkmcnt(5)
  v_mfma_f32_32x32x16_bf16 a[64:79], v[176:179], v[180:183], a[64:79]
  ds_read_b64_tr_b16 v[112:113], v10 offset:20480
  v_accvgpr_read_b32 v87, a23
  v_mul_f32 v87, v87, v58
  buffer_load_dwordx4 a[120:123], v3, s[24:27], s62 offen offset:2048
  v_mfma_f32_32x32x16_bf16 a[80:95], v[176:179], v[184:187], a[80:95]
  ds_read_b64_tr_b16 v[114:115], v10 offset:22528
  ds_read_b128 v[116:119], v11 offset:62464
  v_accvgpr_read_b32 v88, a24
  v_mul_f32 v88, v88, v58
  v_accvgpr_read_b32 v89, a25
  v_mul_f32 v89, v89, v58
  v_accvgpr_read_b32 v90, a26
  v_mul_f32 v90, v90, v58
  v_mfma_f32_32x32x16_bf16 a[96:111], v[176:179], v[188:191], a[96:111]
  ds_read_b128 v[120:123], v11 offset:21504
  ds_read_b128 v[124:127], v11 offset:13312
  buffer_load_dwordx4 a[124:127], v3, s[24:27], s62 offen offset:3072
  v_accvgpr_read_b32 v91, a27
  v_mul_f32 v91, v91, v58
  s_waitcnt lgkmcnt(5)
  v_mfma_f32_32x32x16_bf16 a[64:79], v[96:99], v[100:103], a[64:79]
  ds_read_b64_tr_b16 v[160:161], v10 offset:24576
  v_accvgpr_read_b32 v92, a28
  v_mul_f32 v92, v92, v58
  s_add_u32 s62, s56, 229376
  buffer_load_dwordx4 v[144:147], v3, s[24:27], s62 offen offset:0
  v_mfma_f32_32x32x16_bf16 a[80:95], v[96:99], v[104:107], a[80:95]
  ds_read_b64_tr_b16 v[162:163], v10 offset:26624
  ds_read_b128 v[164:167], v11 offset:63488
  v_accvgpr_read_b32 v93, a29
  v_mul_f32 v93, v93, v58
  v_accvgpr_read_b32 v94, a30
  v_mul_f32 v94, v94, v58
  v_accvgpr_read_b32 v95, a31
  v_mul_f32 v95, v95, v58
  v_mfma_f32_32x32x16_bf16 a[96:111], v[96:99], v[108:111], a[96:111]
  ds_read_b128 v[168:171], v11 offset:22528
  ds_read_b128 v[172:175], v11 offset:14336
  buffer_load_dwordx4 v[148:151], v3, s[24:27], s62 offen offset:1024
  s_waitcnt lgkmcnt(5)
  v_mfma_f32_32x32x16_bf16 a[64:79], v[112:115], v[116:119], a[64:79]
  ds_read_b64_tr_b16 v[176:177], v10 offset:28672
  ds_read_b128 v[46:49], v61 offset:6144
  ds_read_b128 v[50:53], v61 offset:6160
  s_waitcnt lgkmcnt(0)
  v_add_f32 v46, v46, v47
  v_add_f32 v48, v48, v49
  v_add_f32 v50, v50, v51
  v_add_f32 v52, v52, v53
  v_add_f32 v46, v46, v48
  v_add_f32 v50, v50, v52
  v_add_f32 v46, v46, v50
  v_rcp_f32 v26, v46
  s_nop 0
  v_mul_f32 v59, v59, v26
  v_mfma_f32_32x32x16_bf16 a[80:95], v[112:115], v[120:123], a[80:95]
  ds_read_b64_tr_b16 v[178:179], v10 offset:30720
  ds_read_b128 v[180:183], v11 offset:64512
  v_accvgpr_read_b32 v128, a32
  v_mul_f32 v128, v128, v59
  v_mfma_f32_32x32x16_bf16 a[96:111], v[112:115], v[124:127], a[96:111]
  ds_read_b128 v[184:187], v11 offset:23552
  ds_read_b128 v[188:191], v11 offset:15360
  buffer_load_dwordx4 v[152:155], v3, s[24:27], s62 offen offset:2048
  v_accvgpr_read_b32 v129, a33
  v_mul_f32 v129, v129, v59
  v_accvgpr_read_b32 v130, a34
  v_mul_f32 v130, v130, v59
  v_mfma_f32_32x32x16_bf16 a[64:79], v[160:163], v[164:167], a[64:79]
  v_accvgpr_read_b32 v131, a35
  v_mul_f32 v131, v131, v59
  buffer_load_dwordx4 v[156:159], v3, s[24:27], s62 offen offset:3072
  v_accvgpr_read_b32 v132, a36
  v_mul_f32 v132, v132, v59
  v_mfma_f32_32x32x16_bf16 a[80:95], v[160:163], v[168:171], a[80:95]
  v_accvgpr_read_b32 v133, a37
  v_mul_f32 v133, v133, v59
  s_add_u32 s62, s56, 233472
  buffer_load_dwordx4 v[32:35], v3, s[24:27], s62 offen offset:0
  v_mfma_f32_32x32x16_bf16 a[96:111], v[160:163], v[172:175], a[96:111]
  v_accvgpr_read_b32 v134, a38
  v_mul_f32 v134, v134, v59
  v_accvgpr_read_b32 v135, a39
  v_mul_f32 v135, v135, v59
  v_accvgpr_read_b32 v136, a40
  v_mul_f32 v136, v136, v59
  buffer_load_dwordx4 v[36:39], v3, s[24:27], s62 offen offset:1024
  s_waitcnt lgkmcnt(0)
  v_mfma_f32_32x32x16_bf16 a[64:79], v[176:179], v[180:183], a[64:79]
  v_accvgpr_read_b32 v137, a41
  v_mul_f32 v137, v137, v59
  v_accvgpr_read_b32 v138, a42
  v_mul_f32 v138, v138, v59
  buffer_load_dwordx4 v[40:43], v3, s[24:27], s62 offen offset:2048
  v_mfma_f32_32x32x16_bf16 a[80:95], v[176:179], v[184:187], a[80:95]
  v_accvgpr_read_b32 v139, a43
  v_mul_f32 v139, v139, v59
  v_accvgpr_read_b32 v140, a44
  v_mul_f32 v140, v140, v59
  v_accvgpr_read_b32 v141, a45
  v_mul_f32 v141, v141, v59
  v_mfma_f32_32x32x16_bf16 a[96:111], v[176:179], v[188:191], a[96:111]
  buffer_load_dwordx4 v[16:19], v3, s[24:27], s62 offen offset:3072
  v_accvgpr_read_b32 v142, a46
  v_mul_f32 v142, v142, v59
  v_accvgpr_read_b32 v143, a47
  v_mul_f32 v143, v143, v59
  v_accvgpr_read_b32 v96, a64
  v_accvgpr_read_b32 v97, a65
  v_accvgpr_read_b32 v98, a66
  v_accvgpr_read_b32 v99, a67
  v_accvgpr_read_b32 v100, a68
  v_accvgpr_read_b32 v101, a69
  v_accvgpr_read_b32 v102, a70
  v_accvgpr_read_b32 v103, a71
  v_accvgpr_read_b32 v104, a72
  v_accvgpr_read_b32 v105, a73
  v_accvgpr_read_b32 v106, a74
  v_accvgpr_read_b32 v107, a75
  v_accvgpr_read_b32 v108, a76
  v_accvgpr_read_b32 v109, a77
  v_accvgpr_read_b32 v110, a78
  v_accvgpr_read_b32 v111, a79
  v_fma_f32 v64, v96, v24, v64
  v_fma_f32 v65, v97, v24, v65
  v_fma_f32 v66, v98, v24, v66
  v_fma_f32 v67, v99, v24, v67
  v_fma_f32 v68, v100, v24, v68
  v_fma_f32 v69, v101, v24, v69
  v_fma_f32 v70, v102, v24, v70
  v_fma_f32 v71, v103, v24, v71
  v_fma_f32 v72, v104, v24, v72
  v_fma_f32 v73, v105, v24, v73
  v_fma_f32 v74, v106, v24, v74
  v_fma_f32 v75, v107, v24, v75
  v_fma_f32 v76, v108, v24, v76
  v_fma_f32 v77, v109, v24, v77
  v_fma_f32 v78, v110, v24, v78
  v_fma_f32 v79, v111, v24, v79
  v_cvt_pk_bf16_f32 v64, v64, v65
  v_cvt_pk_bf16_f32 v65, v66, v67
  v_cvt_pk_bf16_f32 v66, v68, v69
  v_cvt_pk_bf16_f32 v67, v70, v71
  v_cvt_pk_bf16_f32 v68, v72, v73
  v_cvt_pk_bf16_f32 v69, v74, v75
  v_cvt_pk_bf16_f32 v70, v76, v77
  v_cvt_pk_bf16_f32 v71, v78, v79
  v_permlane32_swap_b32 v64, v66
  v_permlane32_swap_b32 v65, v67
  ds_write_b128 v27, v[64:67] offset:0
  v_permlane32_swap_b32 v68, v70
  v_permlane32_swap_b32 v69, v71
  ds_write_b128 v27, v[68:71] offset:512
  v_accvgpr_read_b32 v112, a80
  v_accvgpr_read_b32 v113, a81
  v_accvgpr_read_b32 v114, a82
  v_accvgpr_read_b32 v115, a83
  v_accvgpr_read_b32 v116, a84
  v_accvgpr_read_b32 v117, a85
  v_accvgpr_read_b32 v118, a86
  v_accvgpr_read_b32 v119, a87
  v_accvgpr_read_b32 v120, a88
  v_accvgpr_read_b32 v121, a89
  v_accvgpr_read_b32 v122, a90
  v_accvgpr_read_b32 v123, a91
  v_accvgpr_read_b32 v124, a92
  v_accvgpr_read_b32 v125, a93
  v_accvgpr_read_b32 v126, a94
  v_accvgpr_read_b32 v127, a95
  v_fma_f32 v80, v112, v25, v80
  v_fma_f32 v81, v113, v25, v81
  v_fma_f32 v82, v114, v25, v82
  v_fma_f32 v83, v115, v25, v83
  v_fma_f32 v84, v116, v25, v84
  v_fma_f32 v85, v117, v25, v85
  v_fma_f32 v86, v118, v25, v86
  v_fma_f32 v87, v119, v25, v87
  v_fma_f32 v88, v120, v25, v88
  v_fma_f32 v89, v121, v25, v89
  v_fma_f32 v90, v122, v25, v90
  v_fma_f32 v91, v123, v25, v91
  v_fma_f32 v92, v124, v25, v92
  v_fma_f32 v93, v125, v25, v93
  v_fma_f32 v94, v126, v25, v94
  v_fma_f32 v95, v127, v25, v95
  v_cvt_pk_bf16_f32 v80, v80, v81
  v_cvt_pk_bf16_f32 v81, v82, v83
  v_cvt_pk_bf16_f32 v82, v84, v85
  v_cvt_pk_bf16_f32 v83, v86, v87
  v_cvt_pk_bf16_f32 v84, v88, v89
  v_cvt_pk_bf16_f32 v85, v90, v91
  v_cvt_pk_bf16_f32 v86, v92, v93
  v_cvt_pk_bf16_f32 v87, v94, v95
  v_permlane32_swap_b32 v80, v82
  v_permlane32_swap_b32 v81, v83
  ds_write_b128 v28, v[80:83] offset:0
  v_permlane32_swap_b32 v84, v86
  v_permlane32_swap_b32 v85, v87
  ds_write_b128 v28, v[84:87] offset:512
  v_accvgpr_read_b32 v96, a96
  v_accvgpr_read_b32 v97, a97
  v_accvgpr_read_b32 v98, a98
  v_accvgpr_read_b32 v99, a99
  v_accvgpr_read_b32 v100, a100
  v_accvgpr_read_b32 v101, a101
  v_accvgpr_read_b32 v102, a102
  v_accvgpr_read_b32 v103, a103
  v_accvgpr_read_b32 v104, a104
  v_accvgpr_read_b32 v105, a105
  v_accvgpr_read_b32 v106, a106
  v_accvgpr_read_b32 v107, a107
  v_accvgpr_read_b32 v108, a108
  v_accvgpr_read_b32 v109, a109
  v_accvgpr_read_b32 v110, a110
  v_accvgpr_read_b32 v111, a111
  v_fma_f32 v128, v96, v26, v128
  v_fma_f32 v129, v97, v26, v129
  v_fma_f32 v130, v98, v26, v130
  v_fma_f32 v131, v99, v26, v131
  v_fma_f32 v132, v100, v26, v132
  v_fma_f32 v133, v101, v26, v133
  v_fma_f32 v134, v102, v26, v134
  v_fma_f32 v135, v103, v26, v135
  v_fma_f32 v136, v104, v26, v136
  v_fma_f32 v137, v105, v26, v137
  v_fma_f32 v138, v106, v26, v138
  v_fma_f32 v139, v107, v26, v139
  v_fma_f32 v140, v108, v26, v140
  v_fma_f32 v141, v109, v26, v141
  v_fma_f32 v142, v110, v26, v142
  v_fma_f32 v143, v111, v26, v143
  v_cvt_pk_bf16_f32 v128, v128, v129
  v_cvt_pk_bf16_f32 v129, v130, v131
  v_cvt_pk_bf16_f32 v130, v132, v133
  v_cvt_pk_bf16_f32 v131, v134, v135
  v_cvt_pk_bf16_f32 v132, v136, v137
  v_cvt_pk_bf16_f32 v133, v138, v139
  v_cvt_pk_bf16_f32 v134, v140, v141
  v_cvt_pk_bf16_f32 v135, v142, v143
  v_permlane32_swap_b32 v128, v130
  v_permlane32_swap_b32 v129, v131
  ds_write_b128 v29, v[128:131] offset:0
  v_permlane32_swap_b32 v132, v134
  v_permlane32_swap_b32 v133, v135
  ds_write_b128 v29, v[132:135] offset:512
  v_add_u32 v8, 0x10000, v11
  s_mov_b32 s68, 0x05040100
  s_mov_b32 s69, 0x07060302
  s_lshl_b32 s4, s37, 4
  s_lshr_b32 s5, s39, 1
  s_add_u32 s4, s4, s5
  s_mul_i32 s4, s4, 49152
  s_mul_i32 s5, s3, 12288
  s_add_u32 s4, s4, s5
  s_add_u32 s57, s4, 0x2000000
  v_perm_b32 v112, v196, v192, s68
  v_perm_b32 v116, v196, v192, s69
  v_perm_b32 v113, v204, v200, s68
  v_perm_b32 v117, v204, v200, s69
  v_perm_b32 v114, v212, v208, s68
  v_perm_b32 v118, v212, v208, s69
  v_perm_b32 v115, v220, v216, s68
  v_perm_b32 v119, v220, v216, s69
  v_accvgpr_read_b32 v48, a224
  v_accvgpr_read_b32 v49, a228
  v_perm_b32 v120, v49, v48, s68
  v_perm_b32 v124, v49, v48, s69
  v_accvgpr_read_b32 v50, a232
  v_accvgpr_read_b32 v51, a236
  v_perm_b32 v121, v51, v50, s68
  v_perm_b32 v125, v51, v50, s69
  v_accvgpr_read_b32 v52, a240
  v_accvgpr_read_b32 v53, a244
  v_perm_b32 v122, v53, v52, s68
  v_perm_b32 v126, v53, v52, s69
  v_accvgpr_read_b32 v54, a248
  v_accvgpr_read_b32 v55, a252
  v_perm_b32 v123, v55, v54, s68
  v_perm_b32 v127, v55, v54, s69
  s_waitcnt lgkmcnt(0)
  s_barrier
  ds_read_b128 a[0:3], v8 offset:0
  ds_read_b128 a[4:7], v8 offset:1024
  ds_read_b128 a[8:11], v8 offset:2048
  ds_read_b128 a[12:15], v8 offset:3072
  ds_read_b128 a[16:19], v8 offset:4096
  ds_read_b128 a[20:23], v8 offset:5120
  s_waitcnt lgkmcnt(3)
  v_mfma_f32_16x16x32_bf16 v[64:67], v[112:115], a[0:3], 0
  ds_read_b128 a[24:27], v8 offset:6144
  ds_read_b128 a[28:31], v8 offset:7168
  ds_read_b128 a[32:35], v8 offset:8192
  s_waitcnt vmcnt(28)
  v_mfma_f32_16x16x32_bf16 v[68:71], v[116:119], a[0:3], 0
  v_accvgpr_read_b32 v48, a128
  v_accvgpr_read_b32 v49, a132
  v_perm_b32 v128, v49, v48, s68
  v_perm_b32 v132, v49, v48, s69
  v_mfma_f32_16x16x32_bf16 v[72:75], v[112:115], a[4:7], 0
  v_accvgpr_read_b32 v50, a136
  v_accvgpr_read_b32 v51, a140
  v_perm_b32 v129, v51, v50, s68
  v_perm_b32 v133, v51, v50, s69
  v_mfma_f32_16x16x32_bf16 v[76:79], v[116:119], a[4:7], 0
  v_mfma_f32_16x16x32_bf16 v[80:83], v[112:115], a[8:11], 0
  v_accvgpr_read_b32 v52, a144
  v_accvgpr_read_b32 v53, a148
  v_perm_b32 v130, v53, v52, s68
  v_perm_b32 v134, v53, v52, s69
  v_mfma_f32_16x16x32_bf16 v[84:87], v[116:119], a[8:11], 0
  v_accvgpr_read_b32 v54, a152
  v_accvgpr_read_b32 v55, a156
  v_perm_b32 v131, v55, v54, s68
  v_perm_b32 v135, v55, v54, s69
  s_waitcnt lgkmcnt(3)
  v_mfma_f32_16x16x32_bf16 v[64:67], v[120:123], a[12:15], v[64:67]
  ds_read_b128 a[36:39], v8 offset:9216
  ds_read_b128 a[40:43], v8 offset:10240
  ds_read_b128 a[44:47], v8 offset:11264
  s_waitcnt vmcnt(20)
  v_mfma_f32_16x16x32_bf16 v[68:71], v[124:127], a[12:15], v[68:71]
  v_accvgpr_read_b32 v48, a160
  v_accvgpr_read_b32 v49, a164
  v_perm_b32 v136, v49, v48, s68
  v_perm_b32 v140, v49, v48, s69
  v_mfma_f32_16x16x32_bf16 v[72:75], v[120:123], a[16:19], v[72:75]
  v_accvgpr_read_b32 v50, a168
  v_accvgpr_read_b32 v51, a172
  v_perm_b32 v137, v51, v50, s68
  v_perm_b32 v141, v51, v50, s69
  v_mfma_f32_16x16x32_bf16 v[76:79], v[124:127], a[16:19], v[76:79]
  v_mfma_f32_16x16x32_bf16 v[80:83], v[120:123], a[20:23], v[80:83]
  v_accvgpr_read_b32 v52, a176
  v_accvgpr_read_b32 v53, a180
  v_perm_b32 v138, v53, v52, s68
  v_perm_b32 v142, v53, v52, s69
  v_mfma_f32_16x16x32_bf16 v[84:87], v[124:127], a[20:23], v[84:87]
  v_accvgpr_read_b32 v54, a184
  v_accvgpr_read_b32 v55, a188
  v_perm_b32 v139, v55, v54, s68
  v_perm_b32 v143, v55, v54, s69
  s_waitcnt lgkmcnt(3)
  v_mfma_f32_16x16x32_bf16 v[64:67], v[128:131], a[24:27], v[64:67]
  ds_read_b128 a[64:67], v8 offset:12288
  ds_read_b128 a[68:71], v8 offset:13312
  ds_read_b128 a[72:75], v8 offset:14336
  s_waitcnt vmcnt(12)
  v_mfma_f32_16x16x32_bf16 v[68:71], v[132:135], a[24:27], v[68:71]
  v_accvgpr_read_b32 v48, a192
  v_accvgpr_read_b32 v49, a196
  v_perm_b32 v112, v49, v48, s68
  v_perm_b32 v116, v49, v48, s69
  v_mfma_f32_16x16x32_bf16 v[72:75], v[128:131], a[28:31], v[72:75]
  v_accvgpr_read_b32 v50, a200
  v_accvgpr_read_b32 v51, a204
  v_perm_b32 v113, v51, v50, s68
  v_perm_b32 v117, v51, v50, s69
  v_mfma_f32_16x16x32_bf16 v[76:79], v[132:135], a[28:31], v[76:79]
  v_mfma_f32_16x16x32_bf16 v[80:83], v[128:131], a[32:35], v[80:83]
  v_accvgpr_read_b32 v52, a208
  v_accvgpr_read_b32 v53, a212
  v_perm_b32 v114, v53, v52, s68
  v_perm_b32 v118, v53, v52, s69
  v_mfma_f32_16x16x32_bf16 v[84:87], v[132:135], a[32:35], v[84:87]
  v_accvgpr_read_b32 v54, a216
  v_accvgpr_read_b32 v55, a220
  v_perm_b32 v115, v55, v54, s68
  v_perm_b32 v119, v55, v54, s69
  s_waitcnt lgkmcnt(3)
  v_mfma_f32_16x16x32_bf16 v[64:67], v[136:139], a[36:39], v[64:67]
  ds_read_b128 a[88:91], v8 offset:26624
  ds_read_b128 a[92:95], v8 offset:27648
  ds_read_b128 a[96:99], v8 offset:28672
  s_waitcnt vmcnt(8)
  v_mfma_f32_16x16x32_bf16 v[68:71], v[140:143], a[36:39], v[68:71]
  v_accvgpr_read_b32 v48, a48
  v_accvgpr_read_b32 v49, a52
  v_perm_b32 v120, v49, v48, s68
  v_perm_b32 v124, v49, v48, s69
  v_mfma_f32_16x16x32_bf16 v[72:75], v[136:139], a[40:43], v[72:75]
  v_accvgpr_read_b32 v50, a56
  v_accvgpr_read_b32 v51, a60
  v_perm_b32 v121, v51, v50, s68
  v_perm_b32 v125, v51, v50, s69
  v_mfma_f32_16x16x32_bf16 v[76:79], v[140:143], a[40:43], v[76:79]
  v_mfma_f32_16x16x32_bf16 v[80:83], v[136:139], a[44:47], v[80:83]
  v_accvgpr_read_b32 v52, a112
  v_accvgpr_read_b32 v53, a116
  v_perm_b32 v122, v53, v52, s68
  v_perm_b32 v126, v53, v52, s69
  v_mfma_f32_16x16x32_bf16 v[84:87], v[140:143], a[44:47], v[84:87]
  v_accvgpr_read_b32 v54, a120
  v_accvgpr_read_b32 v55, a124
  v_perm_b32 v123, v55, v54, s68
  v_perm_b32 v127, v55, v54, s69
  s_waitcnt lgkmcnt(3)
  v_mfma_f32_16x16x32_bf16 v[64:67], v[112:115], a[64:67], v[64:67]
  ds_read_b128 a[76:79], v8 offset:23552
  ds_read_b128 a[80:83], v8 offset:24576
  v_mfma_f32_16x16x32_bf16 v[68:71], v[116:119], a[64:67], v[68:71]
  ds_read_b128 a[84:87], v8 offset:25600
  v_mfma_f32_16x16x32_bf16 v[72:75], v[112:115], a[68:71], v[72:75]
  v_perm_b32 v128, v228, v224, s68
  v_perm_b32 v132, v228, v224, s69
  v_mfma_f32_16x16x32_bf16 v[76:79], v[116:119], a[68:71], v[76:79]
  v_perm_b32 v129, v236, v232, s68
  v_perm_b32 v133, v236, v232, s69
  v_mfma_f32_16x16x32_bf16 v[80:83], v[112:115], a[72:75], v[80:83]
  v_perm_b32 v130, v244, v240, s68
  v_perm_b32 v134, v244, v240, s69
  v_mfma_f32_16x16x32_bf16 v[84:87], v[116:119], a[72:75], v[84:87]
  v_perm_b32 v131, v252, v248, s68
  v_perm_b32 v135, v252, v248, s69
  s_waitcnt lgkmcnt(3)
  v_mfma_f32_16x16x32_bf16 v[64:67], v[120:123], a[88:91], v[64:67]
  ds_read_b128 a[100:103], v8 offset:29696
  ds_read_b128 a[104:107], v8 offset:30720
  v_mfma_f32_16x16x32_bf16 v[68:71], v[124:127], a[88:91], v[68:71]
  ds_read_b128 a[108:111], v8 offset:31744
  s_waitcnt vmcnt(0)
  v_mfma_f32_16x16x32_bf16 v[72:75], v[120:123], a[92:95], v[72:75]
  v_perm_b32 v136, v148, v144, s68
  v_perm_b32 v140, v148, v144, s69
  v_mfma_f32_16x16x32_bf16 v[76:79], v[124:127], a[92:95], v[76:79]
  v_perm_b32 v137, v156, v152, s68
  v_perm_b32 v141, v156, v152, s69
  v_mfma_f32_16x16x32_bf16 v[80:83], v[120:123], a[96:99], v[80:83]
  v_perm_b32 v138, v36, v32, s68
  v_perm_b32 v142, v36, v32, s69
  v_mfma_f32_16x16x32_bf16 v[84:87], v[124:127], a[96:99], v[84:87]
  v_perm_b32 v139, v16, v40, s68
  v_perm_b32 v143, v16, v40, s69
  s_waitcnt lgkmcnt(3)
  v_mfma_f32_16x16x32_bf16 v[64:67], v[128:131], a[76:79], v[64:67]
  v_perm_b32 v112, v197, v193, s68
  v_perm_b32 v116, v197, v193, s69
  v_mfma_f32_16x16x32_bf16 v[68:71], v[132:135], a[76:79], v[68:71]
  v_mfma_f32_16x16x32_bf16 v[72:75], v[128:131], a[80:83], v[72:75]
  v_perm_b32 v113, v205, v201, s68
  v_perm_b32 v117, v205, v201, s69
  v_mfma_f32_16x16x32_bf16 v[76:79], v[132:135], a[80:83], v[76:79]
  v_perm_b32 v114, v213, v209, s68
  v_perm_b32 v118, v213, v209, s69
  v_mfma_f32_16x16x32_bf16 v[80:83], v[128:131], a[84:87], v[80:83]
  v_mfma_f32_16x16x32_bf16 v[84:87], v[132:135], a[84:87], v[84:87]
  v_perm_b32 v115, v221, v217, s68
  v_perm_b32 v119, v221, v217, s69
  s_waitcnt lgkmcnt(0)
  v_mfma_f32_16x16x32_bf16 v[64:67], v[136:139], a[100:103], v[64:67]
  v_accvgpr_read_b32 v48, a225
  v_accvgpr_read_b32 v49, a229
  v_perm_b32 v120, v49, v48, s68
  v_perm_b32 v124, v49, v48, s69
  v_mfma_f32_16x16x32_bf16 v[68:71], v[140:143], a[100:103], v[68:71]
  v_mfma_f32_16x16x32_bf16 v[72:75], v[136:139], a[104:107], v[72:75]
  v_accvgpr_read_b32 v50, a233
  v_accvgpr_read_b32 v51, a237
  v_perm_b32 v121, v51, v50, s68
  v_perm_b32 v125, v51, v50, s69
  v_mfma_f32_16x16x32_bf16 v[76:79], v[140:143], a[104:107], v[76:79]
  v_accvgpr_read_b32 v52, a241
  v_accvgpr_read_b32 v53, a245
  v_perm_b32 v122, v53, v52, s68
  v_perm_b32 v126, v53, v52, s69
  v_mfma_f32_16x16x32_bf16 v[80:83], v[136:139], a[108:111], v[80:83]
  v_mfma_f32_16x16x32_bf16 v[84:87], v[140:143], a[108:111], v[84:87]
  v_accvgpr_read_b32 v54, a249
  v_accvgpr_read_b32 v55, a253
  v_perm_b32 v123, v55, v54, s68
  v_perm_b32 v127, v55, v54, s69
  v_mfma_f32_16x16x32_bf16 v[88:91], v[112:115], a[0:3], 0
  v_mfma_f32_16x16x32_bf16 v[92:95], v[116:119], a[0:3], 0
  v_cvt_pk_bf16_f32 v160, v64, v68
  v_cvt_pk_bf16_f32 v161, v65, v69
  v_cvt_pk_bf16_f32 v162, v66, v70
  v_cvt_pk_bf16_f32 v163, v67, v71
  s_add_u32 s4, s57, 0
  buffer_store_dwordx4 v[160:163], v11, s[28:31], s4 offen offset:0 sc1
  v_mfma_f32_16x16x32_bf16 v[96:99], v[112:115], a[4:7], 0
  v_accvgpr_read_b32 v48, a129
  v_accvgpr_read_b32 v49, a133
  v_perm_b32 v128, v49, v48, s68
  v_perm_b32 v132, v49, v48, s69
  v_mfma_f32_16x16x32_bf16 v[100:103], v[116:119], a[4:7], 0
  v_accvgpr_read_b32 v50, a137
  v_accvgpr_read_b32 v51, a141
  v_perm_b32 v129, v51, v50, s68
  v_perm_b32 v133, v51, v50, s69
  v_mfma_f32_16x16x32_bf16 v[104:107], v[112:115], a[8:11], 0
  v_accvgpr_read_b32 v52, a145
  v_accvgpr_read_b32 v53, a149
  v_perm_b32 v130, v53, v52, s68
  v_perm_b32 v134, v53, v52, s69
  v_mfma_f32_16x16x32_bf16 v[108:111], v[116:119], a[8:11], 0
  v_accvgpr_read_b32 v54, a153
  v_accvgpr_read_b32 v55, a157
  v_perm_b32 v131, v55, v54, s68
  v_perm_b32 v135, v55, v54, s69
  v_mfma_f32_16x16x32_bf16 v[88:91], v[120:123], a[12:15], v[88:91]
  v_mfma_f32_16x16x32_bf16 v[92:95], v[124:127], a[12:15], v[92:95]
  v_cvt_pk_bf16_f32 v164, v72, v76
  v_cvt_pk_bf16_f32 v165, v73, v77
  v_cvt_pk_bf16_f32 v166, v74, v78
  v_cvt_pk_bf16_f32 v167, v75, v79
  s_add_u32 s4, s57, 0
  buffer_store_dwordx4 v[164:167], v11, s[28:31], s4 offen offset:1024 sc1
  v_mfma_f32_16x16x32_bf16 v[96:99], v[120:123], a[16:19], v[96:99]
  v_accvgpr_read_b32 v48, a161
  v_accvgpr_read_b32 v49, a165
  v_perm_b32 v136, v49, v48, s68
  v_perm_b32 v140, v49, v48, s69
  v_mfma_f32_16x16x32_bf16 v[100:103], v[124:127], a[16:19], v[100:103]
  v_accvgpr_read_b32 v50, a169
  v_accvgpr_read_b32 v51, a173
  v_perm_b32 v137, v51, v50, s68
  v_perm_b32 v141, v51, v50, s69
  v_mfma_f32_16x16x32_bf16 v[104:107], v[120:123], a[20:23], v[104:107]
  v_accvgpr_read_b32 v52, a177
  v_accvgpr_read_b32 v53, a181
  v_perm_b32 v138, v53, v52, s68
  v_perm_b32 v142, v53, v52, s69
  v_mfma_f32_16x16x32_bf16 v[108:111], v[124:127], a[20:23], v[108:111]
  v_accvgpr_read_b32 v54, a185
  v_accvgpr_read_b32 v55, a189
  v_perm_b32 v139, v55, v54, s68
  v_perm_b32 v143, v55, v54, s69
  v_mfma_f32_16x16x32_bf16 v[88:91], v[128:131], a[24:27], v[88:91]
  v_mfma_f32_16x16x32_bf16 v[92:95], v[132:135], a[24:27], v[92:95]
  v_cvt_pk_bf16_f32 v168, v80, v84
  v_cvt_pk_bf16_f32 v169, v81, v85
  v_cvt_pk_bf16_f32 v170, v82, v86
  v_cvt_pk_bf16_f32 v171, v83, v87
  s_add_u32 s4, s57, 0
  buffer_store_dwordx4 v[168:171], v11, s[28:31], s4 offen offset:2048 sc1
  v_mfma_f32_16x16x32_bf16 v[96:99], v[128:131], a[28:31], v[96:99]
  v_accvgpr_read_b32 v48, a193
  v_accvgpr_read_b32 v49, a197
  v_perm_b32 v112, v49, v48, s68
  v_perm_b32 v116, v49, v48, s69
  v_mfma_f32_16x16x32_bf16 v[100:103], v[132:135], a[28:31], v[100:103]
  v_accvgpr_read_b32 v50, a201
  v_accvgpr_read_b32 v51, a205
  v_perm_b32 v113, v51, v50, s68
  v_perm_b32 v117, v51, v50, s69
  v_mfma_f32_16x16x32_bf16 v[104:107], v[128:131], a[32:35], v[104:107]
  v_accvgpr_read_b32 v52, a209
  v_accvgpr_read_b32 v53, a213
  v_perm_b32 v114, v53, v52, s68
  v_perm_b32 v118, v53, v52, s69
  v_mfma_f32_16x16x32_bf16 v[108:111], v[132:135], a[32:35], v[108:111]
  v_accvgpr_read_b32 v54, a217
  v_accvgpr_read_b32 v55, a221
  v_perm_b32 v115, v55, v54, s68
  v_perm_b32 v119, v55, v54, s69
  v_mfma_f32_16x16x32_bf16 v[88:91], v[136:139], a[36:39], v[88:91]
  v_accvgpr_read_b32 v48, a49
  v_accvgpr_read_b32 v49, a53
  v_perm_b32 v120, v49, v48, s68
  v_perm_b32 v124, v49, v48, s69
  v_mfma_f32_16x16x32_bf16 v[92:95], v[140:143], a[36:39], v[92:95]
  v_mfma_f32_16x16x32_bf16 v[96:99], v[136:139], a[40:43], v[96:99]
  v_accvgpr_read_b32 v50, a57
  v_accvgpr_read_b32 v51, a61
  v_perm_b32 v121, v51, v50, s68
  v_perm_b32 v125, v51, v50, s69
  v_mfma_f32_16x16x32_bf16 v[100:103], v[140:143], a[40:43], v[100:103]
  v_accvgpr_read_b32 v52, a113
  v_accvgpr_read_b32 v53, a117
  v_perm_b32 v122, v53, v52, s68
  v_perm_b32 v126, v53, v52, s69
  v_mfma_f32_16x16x32_bf16 v[104:107], v[136:139], a[44:47], v[104:107]
  v_mfma_f32_16x16x32_bf16 v[108:111], v[140:143], a[44:47], v[108:111]
  v_accvgpr_read_b32 v54, a121
  v_accvgpr_read_b32 v55, a125
  v_perm_b32 v123, v55, v54, s68
  v_perm_b32 v127, v55, v54, s69
  v_mfma_f32_16x16x32_bf16 v[88:91], v[112:115], a[64:67], v[88:91]
  v_perm_b32 v128, v229, v225, s68
  v_perm_b32 v132, v229, v225, s69
  v_mfma_f32_16x16x32_bf16 v[92:95], v[116:119], a[64:67], v[92:95]
  v_mfma_f32_16x16x32_bf16 v[96:99], v[112:115], a[68:71], v[96:99]
  v_perm_b32 v129, v237, v233, s68
  v_perm_b32 v133, v237, v233, s69
  v_mfma_f32_16x16x32_bf16 v[100:103], v[116:119], a[68:71], v[100:103]
  v_perm_b32 v130, v245, v241, s68
  v_perm_b32 v134, v245, v241, s69
  v_mfma_f32_16x16x32_bf16 v[104:107], v[112:115], a[72:75], v[104:107]
  v_mfma_f32_16x16x32_bf16 v[108:111], v[116:119], a[72:75], v[108:111]
  v_perm_b32 v131, v253, v249, s68
  v_perm_b32 v135, v253, v249, s69
  v_mfma_f32_16x16x32_bf16 v[88:91], v[120:123], a[88:91], v[88:91]
  v_perm_b32 v136, v149, v145, s68
  v_perm_b32 v140, v149, v145, s69
  v_mfma_f32_16x16x32_bf16 v[92:95], v[124:127], a[88:91], v[92:95]
  v_mfma_f32_16x16x32_bf16 v[96:99], v[120:123], a[92:95], v[96:99]
  v_perm_b32 v137, v157, v153, s68
  v_perm_b32 v141, v157, v153, s69
  v_mfma_f32_16x16x32_bf16 v[100:103], v[124:127], a[92:95], v[100:103]
  v_perm_b32 v138, v37, v33, s68
  v_perm_b32 v142, v37, v33, s69
  v_mfma_f32_16x16x32_bf16 v[104:107], v[120:123], a[96:99], v[104:107]
  v_mfma_f32_16x16x32_bf16 v[108:111], v[124:127], a[96:99], v[108:111]
  v_perm_b32 v139, v17, v41, s68
  v_perm_b32 v143, v17, v41, s69
  v_mfma_f32_16x16x32_bf16 v[88:91], v[128:131], a[76:79], v[88:91]
  v_perm_b32 v112, v198, v194, s68
  v_perm_b32 v116, v198, v194, s69
  v_mfma_f32_16x16x32_bf16 v[92:95], v[132:135], a[76:79], v[92:95]
  v_mfma_f32_16x16x32_bf16 v[96:99], v[128:131], a[80:83], v[96:99]
  v_perm_b32 v113, v206, v202, s68
  v_perm_b32 v117, v206, v202, s69
  v_mfma_f32_16x16x32_bf16 v[100:103], v[132:135], a[80:83], v[100:103]
  v_perm_b32 v114, v214, v210, s68
  v_perm_b32 v118, v214, v210, s69
  v_mfma_f32_16x16x32_bf16 v[104:107], v[128:131], a[84:87], v[104:107]
  v_mfma_f32_16x16x32_bf16 v[108:111], v[132:135], a[84:87], v[108:111]
  v_perm_b32 v115, v222, v218, s68
  v_perm_b32 v119, v222, v218, s69
  v_mfma_f32_16x16x32_bf16 v[88:91], v[136:139], a[100:103], v[88:91]
  v_accvgpr_read_b32 v48, a226
  v_accvgpr_read_b32 v49, a230
  v_perm_b32 v120, v49, v48, s68
  v_perm_b32 v124, v49, v48, s69
  v_mfma_f32_16x16x32_bf16 v[92:95], v[140:143], a[100:103], v[92:95]
  v_mfma_f32_16x16x32_bf16 v[96:99], v[136:139], a[104:107], v[96:99]
  v_accvgpr_read_b32 v50, a234
  v_accvgpr_read_b32 v51, a238
  v_perm_b32 v121, v51, v50, s68
  v_perm_b32 v125, v51, v50, s69
  v_mfma_f32_16x16x32_bf16 v[100:103], v[140:143], a[104:107], v[100:103]
  v_accvgpr_read_b32 v52, a242
  v_accvgpr_read_b32 v53, a246
  v_perm_b32 v122, v53, v52, s68
  v_perm_b32 v126, v53, v52, s69
  v_mfma_f32_16x16x32_bf16 v[104:107], v[136:139], a[108:111], v[104:107]
  v_mfma_f32_16x16x32_bf16 v[108:111], v[140:143], a[108:111], v[108:111]
  v_accvgpr_read_b32 v54, a250
  v_accvgpr_read_b32 v55, a254
  v_perm_b32 v123, v55, v54, s68
  v_perm_b32 v127, v55, v54, s69
  v_mfma_f32_16x16x32_bf16 v[64:67], v[112:115], a[0:3], 0
  v_mfma_f32_16x16x32_bf16 v[68:71], v[116:119], a[0:3], 0
  v_cvt_pk_bf16_f32 v172, v88, v92
  v_cvt_pk_bf16_f32 v173, v89, v93
  v_cvt_pk_bf16_f32 v174, v90, v94
  v_cvt_pk_bf16_f32 v175, v91, v95
  s_add_u32 s4, s57, 3072
  buffer_store_dwordx4 v[172:175], v11, s[28:31], s4 offen offset:0 sc1
  v_mfma_f32_16x16x32_bf16 v[72:75], v[112:115], a[4:7], 0
  v_accvgpr_read_b32 v48, a130
  v_accvgpr_read_b32 v49, a134
  v_perm_b32 v128, v49, v48, s68
  v_perm_b32 v132, v49, v48, s69
  v_mfma_f32_16x16x32_bf16 v[76:79], v[116:119], a[4:7], 0
  v_accvgpr_read_b32 v50, a138
  v_accvgpr_read_b32 v51, a142
  v_perm_b32 v129, v51, v50, s68
  v_perm_b32 v133, v51, v50, s69
  v_mfma_f32_16x16x32_bf16 v[80:83], v[112:115], a[8:11], 0
  v_accvgpr_read_b32 v52, a146
  v_accvgpr_read_b32 v53, a150
  v_perm_b32 v130, v53, v52, s68
  v_perm_b32 v134, v53, v52, s69
  v_mfma_f32_16x16x32_bf16 v[84:87], v[116:119], a[8:11], 0
  v_accvgpr_read_b32 v54, a154
  v_accvgpr_read_b32 v55, a158
  v_perm_b32 v131, v55, v54, s68
  v_perm_b32 v135, v55, v54, s69
  v_mfma_f32_16x16x32_bf16 v[64:67], v[120:123], a[12:15], v[64:67]
  v_mfma_f32_16x16x32_bf16 v[68:71], v[124:127], a[12:15], v[68:71]
  v_cvt_pk_bf16_f32 v160, v96, v100
  v_cvt_pk_bf16_f32 v161, v97, v101
  v_cvt_pk_bf16_f32 v162, v98, v102
  v_cvt_pk_bf16_f32 v163, v99, v103
  s_add_u32 s4, s57, 3072
  buffer_store_dwordx4 v[160:163], v11, s[28:31], s4 offen offset:1024 sc1
  v_mfma_f32_16x16x32_bf16 v[72:75], v[120:123], a[16:19], v[72:75]
  v_accvgpr_read_b32 v48, a162
  v_accvgpr_read_b32 v49, a166
  v_perm_b32 v136, v49, v48, s68
  v_perm_b32 v140, v49, v48, s69
  v_mfma_f32_16x16x32_bf16 v[76:79], v[124:127], a[16:19], v[76:79]
  v_accvgpr_read_b32 v50, a170
  v_accvgpr_read_b32 v51, a174
  v_perm_b32 v137, v51, v50, s68
  v_perm_b32 v141, v51, v50, s69
  v_mfma_f32_16x16x32_bf16 v[80:83], v[120:123], a[20:23], v[80:83]
  v_accvgpr_read_b32 v52, a178
  v_accvgpr_read_b32 v53, a182
  v_perm_b32 v138, v53, v52, s68
  v_perm_b32 v142, v53, v52, s69
  v_mfma_f32_16x16x32_bf16 v[84:87], v[124:127], a[20:23], v[84:87]
  v_accvgpr_read_b32 v54, a186
  v_accvgpr_read_b32 v55, a190
  v_perm_b32 v139, v55, v54, s68
  v_perm_b32 v143, v55, v54, s69
  v_mfma_f32_16x16x32_bf16 v[64:67], v[128:131], a[24:27], v[64:67]
  v_mfma_f32_16x16x32_bf16 v[68:71], v[132:135], a[24:27], v[68:71]
  v_cvt_pk_bf16_f32 v164, v104, v108
  v_cvt_pk_bf16_f32 v165, v105, v109
  v_cvt_pk_bf16_f32 v166, v106, v110
  v_cvt_pk_bf16_f32 v167, v107, v111
  s_add_u32 s4, s57, 3072
  buffer_store_dwordx4 v[164:167], v11, s[28:31], s4 offen offset:2048 sc1
  v_mfma_f32_16x16x32_bf16 v[72:75], v[128:131], a[28:31], v[72:75]
  v_accvgpr_read_b32 v48, a194
  v_accvgpr_read_b32 v49, a198
  v_perm_b32 v112, v49, v48, s68
  v_perm_b32 v116, v49, v48, s69
  v_mfma_f32_16x16x32_bf16 v[76:79], v[132:135], a[28:31], v[76:79]
  v_accvgpr_read_b32 v50, a202
  v_accvgpr_read_b32 v51, a206
  v_perm_b32 v113, v51, v50, s68
  v_perm_b32 v117, v51, v50, s69
  v_mfma_f32_16x16x32_bf16 v[80:83], v[128:131], a[32:35], v[80:83]
  v_accvgpr_read_b32 v52, a210
  v_accvgpr_read_b32 v53, a214
  v_perm_b32 v114, v53, v52, s68
  v_perm_b32 v118, v53, v52, s69
  v_mfma_f32_16x16x32_bf16 v[84:87], v[132:135], a[32:35], v[84:87]
  v_accvgpr_read_b32 v54, a218
  v_accvgpr_read_b32 v55, a222
  v_perm_b32 v115, v55, v54, s68
  v_perm_b32 v119, v55, v54, s69
  v_mfma_f32_16x16x32_bf16 v[64:67], v[136:139], a[36:39], v[64:67]
  v_accvgpr_read_b32 v48, a50
  v_accvgpr_read_b32 v49, a54
  v_perm_b32 v120, v49, v48, s68
  v_perm_b32 v124, v49, v48, s69
  v_mfma_f32_16x16x32_bf16 v[68:71], v[140:143], a[36:39], v[68:71]
  v_mfma_f32_16x16x32_bf16 v[72:75], v[136:139], a[40:43], v[72:75]
  v_accvgpr_read_b32 v50, a58
  v_accvgpr_read_b32 v51, a62
  v_perm_b32 v121, v51, v50, s68
  v_perm_b32 v125, v51, v50, s69
  v_mfma_f32_16x16x32_bf16 v[76:79], v[140:143], a[40:43], v[76:79]
  v_accvgpr_read_b32 v52, a114
  v_accvgpr_read_b32 v53, a118
  v_perm_b32 v122, v53, v52, s68
  v_perm_b32 v126, v53, v52, s69
  v_mfma_f32_16x16x32_bf16 v[80:83], v[136:139], a[44:47], v[80:83]
  v_mfma_f32_16x16x32_bf16 v[84:87], v[140:143], a[44:47], v[84:87]
  v_accvgpr_read_b32 v54, a122
  v_accvgpr_read_b32 v55, a126
  v_perm_b32 v123, v55, v54, s68
  v_perm_b32 v127, v55, v54, s69
  v_mfma_f32_16x16x32_bf16 v[64:67], v[112:115], a[64:67], v[64:67]
  v_perm_b32 v128, v230, v226, s68
  v_perm_b32 v132, v230, v226, s69
  v_mfma_f32_16x16x32_bf16 v[68:71], v[116:119], a[64:67], v[68:71]
  v_mfma_f32_16x16x32_bf16 v[72:75], v[112:115], a[68:71], v[72:75]
  v_perm_b32 v129, v238, v234, s68
  v_perm_b32 v133, v238, v234, s69
  v_mfma_f32_16x16x32_bf16 v[76:79], v[116:119], a[68:71], v[76:79]
  v_perm_b32 v130, v246, v242, s68
  v_perm_b32 v134, v246, v242, s69
  v_mfma_f32_16x16x32_bf16 v[80:83], v[112:115], a[72:75], v[80:83]
  v_mfma_f32_16x16x32_bf16 v[84:87], v[116:119], a[72:75], v[84:87]
  v_perm_b32 v131, v254, v250, s68
  v_perm_b32 v135, v254, v250, s69
  v_mfma_f32_16x16x32_bf16 v[64:67], v[120:123], a[88:91], v[64:67]
  v_perm_b32 v136, v150, v146, s68
  v_perm_b32 v140, v150, v146, s69
  v_mfma_f32_16x16x32_bf16 v[68:71], v[124:127], a[88:91], v[68:71]
  v_mfma_f32_16x16x32_bf16 v[72:75], v[120:123], a[92:95], v[72:75]
  v_perm_b32 v137, v158, v154, s68
  v_perm_b32 v141, v158, v154, s69
  v_mfma_f32_16x16x32_bf16 v[76:79], v[124:127], a[92:95], v[76:79]
  v_perm_b32 v138, v38, v34, s68
  v_perm_b32 v142, v38, v34, s69
  v_mfma_f32_16x16x32_bf16 v[80:83], v[120:123], a[96:99], v[80:83]
  v_mfma_f32_16x16x32_bf16 v[84:87], v[124:127], a[96:99], v[84:87]
  v_perm_b32 v139, v18, v42, s68
  v_perm_b32 v143, v18, v42, s69
  v_mfma_f32_16x16x32_bf16 v[64:67], v[128:131], a[76:79], v[64:67]
  v_perm_b32 v112, v199, v195, s68
  v_perm_b32 v116, v199, v195, s69
  v_mfma_f32_16x16x32_bf16 v[68:71], v[132:135], a[76:79], v[68:71]
  v_mfma_f32_16x16x32_bf16 v[72:75], v[128:131], a[80:83], v[72:75]
  v_perm_b32 v113, v207, v203, s68
  v_perm_b32 v117, v207, v203, s69
  v_mfma_f32_16x16x32_bf16 v[76:79], v[132:135], a[80:83], v[76:79]
  v_perm_b32 v114, v215, v211, s68
  v_perm_b32 v118, v215, v211, s69
  v_mfma_f32_16x16x32_bf16 v[80:83], v[128:131], a[84:87], v[80:83]
  v_mfma_f32_16x16x32_bf16 v[84:87], v[132:135], a[84:87], v[84:87]
  v_perm_b32 v115, v223, v219, s68
  v_perm_b32 v119, v223, v219, s69
  v_mfma_f32_16x16x32_bf16 v[64:67], v[136:139], a[100:103], v[64:67]
  v_accvgpr_read_b32 v48, a227
  v_accvgpr_read_b32 v49, a231
  v_perm_b32 v120, v49, v48, s68
  v_perm_b32 v124, v49, v48, s69
  v_mfma_f32_16x16x32_bf16 v[68:71], v[140:143], a[100:103], v[68:71]
  v_mfma_f32_16x16x32_bf16 v[72:75], v[136:139], a[104:107], v[72:75]
  v_accvgpr_read_b32 v50, a235
  v_accvgpr_read_b32 v51, a239
  v_perm_b32 v121, v51, v50, s68
  v_perm_b32 v125, v51, v50, s69
  v_mfma_f32_16x16x32_bf16 v[76:79], v[140:143], a[104:107], v[76:79]
  v_accvgpr_read_b32 v52, a243
  v_accvgpr_read_b32 v53, a247
  v_perm_b32 v122, v53, v52, s68
  v_perm_b32 v126, v53, v52, s69
  v_mfma_f32_16x16x32_bf16 v[80:83], v[136:139], a[108:111], v[80:83]
  v_mfma_f32_16x16x32_bf16 v[84:87], v[140:143], a[108:111], v[84:87]
  v_accvgpr_read_b32 v54, a251
  v_accvgpr_read_b32 v55, a255
  v_perm_b32 v123, v55, v54, s68
  v_perm_b32 v127, v55, v54, s69
  v_mfma_f32_16x16x32_bf16 v[88:91], v[112:115], a[0:3], 0
  v_mfma_f32_16x16x32_bf16 v[92:95], v[116:119], a[0:3], 0
  v_cvt_pk_bf16_f32 v168, v64, v68
  v_cvt_pk_bf16_f32 v169, v65, v69
  v_cvt_pk_bf16_f32 v170, v66, v70
  v_cvt_pk_bf16_f32 v171, v67, v71
  s_add_u32 s4, s57, 6144
  buffer_store_dwordx4 v[168:171], v11, s[28:31], s4 offen offset:0 sc1
  v_mfma_f32_16x16x32_bf16 v[96:99], v[112:115], a[4:7], 0
  v_accvgpr_read_b32 v48, a131
  v_accvgpr_read_b32 v49, a135
  v_perm_b32 v128, v49, v48, s68
  v_perm_b32 v132, v49, v48, s69
  v_mfma_f32_16x16x32_bf16 v[100:103], v[116:119], a[4:7], 0
  v_accvgpr_read_b32 v50, a139
  v_accvgpr_read_b32 v51, a143
  v_perm_b32 v129, v51, v50, s68
  v_perm_b32 v133, v51, v50, s69
  v_mfma_f32_16x16x32_bf16 v[104:107], v[112:115], a[8:11], 0
  v_accvgpr_read_b32 v52, a147
  v_accvgpr_read_b32 v53, a151
  v_perm_b32 v130, v53, v52, s68
  v_perm_b32 v134, v53, v52, s69
  v_mfma_f32_16x16x32_bf16 v[108:111], v[116:119], a[8:11], 0
  v_accvgpr_read_b32 v54, a155
  v_accvgpr_read_b32 v55, a159
  v_perm_b32 v131, v55, v54, s68
  v_perm_b32 v135, v55, v54, s69
  v_mfma_f32_16x16x32_bf16 v[88:91], v[120:123], a[12:15], v[88:91]
  v_mfma_f32_16x16x32_bf16 v[92:95], v[124:127], a[12:15], v[92:95]
  v_cvt_pk_bf16_f32 v172, v72, v76
  v_cvt_pk_bf16_f32 v173, v73, v77
  v_cvt_pk_bf16_f32 v174, v74, v78
  v_cvt_pk_bf16_f32 v175, v75, v79
  s_add_u32 s4, s57, 6144
  buffer_store_dwordx4 v[172:175], v11, s[28:31], s4 offen offset:1024 sc1
  v_mfma_f32_16x16x32_bf16 v[96:99], v[120:123], a[16:19], v[96:99]
  v_accvgpr_read_b32 v48, a163
  v_accvgpr_read_b32 v49, a167
  v_perm_b32 v136, v49, v48, s68
  v_perm_b32 v140, v49, v48, s69
  v_mfma_f32_16x16x32_bf16 v[100:103], v[124:127], a[16:19], v[100:103]
  v_accvgpr_read_b32 v50, a171
  v_accvgpr_read_b32 v51, a175
  v_perm_b32 v137, v51, v50, s68
  v_perm_b32 v141, v51, v50, s69
  v_mfma_f32_16x16x32_bf16 v[104:107], v[120:123], a[20:23], v[104:107]
  v_accvgpr_read_b32 v52, a179
  v_accvgpr_read_b32 v53, a183
  v_perm_b32 v138, v53, v52, s68
  v_perm_b32 v142, v53, v52, s69
  v_mfma_f32_16x16x32_bf16 v[108:111], v[124:127], a[20:23], v[108:111]
  v_accvgpr_read_b32 v54, a187
  v_accvgpr_read_b32 v55, a191
  v_perm_b32 v139, v55, v54, s68
  v_perm_b32 v143, v55, v54, s69
  v_mfma_f32_16x16x32_bf16 v[88:91], v[128:131], a[24:27], v[88:91]
  v_mfma_f32_16x16x32_bf16 v[92:95], v[132:135], a[24:27], v[92:95]
  v_cvt_pk_bf16_f32 v160, v80, v84
  v_cvt_pk_bf16_f32 v161, v81, v85
  v_cvt_pk_bf16_f32 v162, v82, v86
  v_cvt_pk_bf16_f32 v163, v83, v87
  s_add_u32 s4, s57, 6144
  buffer_store_dwordx4 v[160:163], v11, s[28:31], s4 offen offset:2048 sc1
  v_mfma_f32_16x16x32_bf16 v[96:99], v[128:131], a[28:31], v[96:99]
  v_accvgpr_read_b32 v48, a195
  v_accvgpr_read_b32 v49, a199
  v_perm_b32 v112, v49, v48, s68
  v_perm_b32 v116, v49, v48, s69
  v_mfma_f32_16x16x32_bf16 v[100:103], v[132:135], a[28:31], v[100:103]
  v_accvgpr_read_b32 v50, a203
  v_accvgpr_read_b32 v51, a207
  v_perm_b32 v113, v51, v50, s68
  v_perm_b32 v117, v51, v50, s69
  v_mfma_f32_16x16x32_bf16 v[104:107], v[128:131], a[32:35], v[104:107]
  v_accvgpr_read_b32 v52, a211
  v_accvgpr_read_b32 v53, a215
  v_perm_b32 v114, v53, v52, s68
  v_perm_b32 v118, v53, v52, s69
  v_mfma_f32_16x16x32_bf16 v[108:111], v[132:135], a[32:35], v[108:111]
  v_accvgpr_read_b32 v54, a219
  v_accvgpr_read_b32 v55, a223
  v_perm_b32 v115, v55, v54, s68
  v_perm_b32 v119, v55, v54, s69
  v_mfma_f32_16x16x32_bf16 v[88:91], v[136:139], a[36:39], v[88:91]
  v_accvgpr_read_b32 v48, a51
  v_accvgpr_read_b32 v49, a55
  v_perm_b32 v120, v49, v48, s68
  v_perm_b32 v124, v49, v48, s69
  v_mfma_f32_16x16x32_bf16 v[92:95], v[140:143], a[36:39], v[92:95]
  v_mfma_f32_16x16x32_bf16 v[96:99], v[136:139], a[40:43], v[96:99]
  v_accvgpr_read_b32 v50, a59
  v_accvgpr_read_b32 v51, a63
  v_perm_b32 v121, v51, v50, s68
  v_perm_b32 v125, v51, v50, s69
  v_mfma_f32_16x16x32_bf16 v[100:103], v[140:143], a[40:43], v[100:103]
  v_accvgpr_read_b32 v52, a115
  v_accvgpr_read_b32 v53, a119
  v_perm_b32 v122, v53, v52, s68
  v_perm_b32 v126, v53, v52, s69
  v_mfma_f32_16x16x32_bf16 v[104:107], v[136:139], a[44:47], v[104:107]
  v_mfma_f32_16x16x32_bf16 v[108:111], v[140:143], a[44:47], v[108:111]
  v_accvgpr_read_b32 v54, a123
  v_accvgpr_read_b32 v55, a127
  v_perm_b32 v123, v55, v54, s68
  v_perm_b32 v127, v55, v54, s69
  v_mfma_f32_16x16x32_bf16 v[88:91], v[112:115], a[64:67], v[88:91]
  v_perm_b32 v128, v231, v227, s68
  v_perm_b32 v132, v231, v227, s69
  v_mfma_f32_16x16x32_bf16 v[92:95], v[116:119], a[64:67], v[92:95]
  v_mfma_f32_16x16x32_bf16 v[96:99], v[112:115], a[68:71], v[96:99]
  v_perm_b32 v129, v239, v235, s68
  v_perm_b32 v133, v239, v235, s69
  v_mfma_f32_16x16x32_bf16 v[100:103], v[116:119], a[68:71], v[100:103]
  v_perm_b32 v130, v247, v243, s68
  v_perm_b32 v134, v247, v243, s69
  v_mfma_f32_16x16x32_bf16 v[104:107], v[112:115], a[72:75], v[104:107]
  v_mfma_f32_16x16x32_bf16 v[108:111], v[116:119], a[72:75], v[108:111]
  v_perm_b32 v131, v255, v251, s68
  v_perm_b32 v135, v255, v251, s69
  v_mfma_f32_16x16x32_bf16 v[88:91], v[120:123], a[88:91], v[88:91]
  v_perm_b32 v136, v151, v147, s68
  v_perm_b32 v140, v151, v147, s69
  v_mfma_f32_16x16x32_bf16 v[92:95], v[124:127], a[88:91], v[92:95]
  v_mfma_f32_16x16x32_bf16 v[96:99], v[120:123], a[92:95], v[96:99]
  v_perm_b32 v137, v159, v155, s68
  v_perm_b32 v141, v159, v155, s69
  v_mfma_f32_16x16x32_bf16 v[100:103], v[124:127], a[92:95], v[100:103]
  v_perm_b32 v138, v39, v35, s68
  v_perm_b32 v142, v39, v35, s69
  v_mfma_f32_16x16x32_bf16 v[104:107], v[120:123], a[96:99], v[104:107]
  v_mfma_f32_16x16x32_bf16 v[108:111], v[124:127], a[96:99], v[108:111]
  v_perm_b32 v139, v19, v43, s68
  v_perm_b32 v143, v19, v43, s69
  v_mfma_f32_16x16x32_bf16 v[88:91], v[128:131], a[76:79], v[88:91]
  v_mfma_f32_16x16x32_bf16 v[92:95], v[132:135], a[76:79], v[92:95]
  v_mfma_f32_16x16x32_bf16 v[96:99], v[128:131], a[80:83], v[96:99]
  v_mfma_f32_16x16x32_bf16 v[100:103], v[132:135], a[80:83], v[100:103]
  v_mfma_f32_16x16x32_bf16 v[104:107], v[128:131], a[84:87], v[104:107]
  v_mfma_f32_16x16x32_bf16 v[108:111], v[132:135], a[84:87], v[108:111]
  v_mfma_f32_16x16x32_bf16 v[88:91], v[136:139], a[100:103], v[88:91]
  v_mfma_f32_16x16x32_bf16 v[92:95], v[140:143], a[100:103], v[92:95]
  v_mfma_f32_16x16x32_bf16 v[96:99], v[136:139], a[104:107], v[96:99]
  v_mfma_f32_16x16x32_bf16 v[100:103], v[140:143], a[104:107], v[100:103]
  s_nop 5
  v_cvt_pk_bf16_f32 v164, v88, v92
  v_cvt_pk_bf16_f32 v165, v89, v93
  v_cvt_pk_bf16_f32 v166, v90, v94
  v_cvt_pk_bf16_f32 v167, v91, v95
  s_add_u32 s4, s57, 9216
  buffer_store_dwordx4 v[164:167], v11, s[28:31], s4 offen offset:0 sc1
  v_mfma_f32_16x16x32_bf16 v[104:107], v[136:139], a[108:111], v[104:107]
  v_mfma_f32_16x16x32_bf16 v[108:111], v[140:143], a[108:111], v[108:111]
  v_cvt_pk_bf16_f32 v168, v96, v100
  v_cvt_pk_bf16_f32 v169, v97, v101
  v_cvt_pk_bf16_f32 v170, v98, v102
  v_cvt_pk_bf16_f32 v171, v99, v103
  s_add_u32 s4, s57, 9216
  buffer_store_dwordx4 v[168:171], v11, s[28:31], s4 offen offset:1024 sc1
  s_nop 1
  v_cvt_pk_bf16_f32 v172, v104, v108
  v_cvt_pk_bf16_f32 v173, v105, v109
  v_cvt_pk_bf16_f32 v174, v106, v110
  v_cvt_pk_bf16_f32 v175, v107, v111
  s_add_u32 s4, s57, 9216
  buffer_store_dwordx4 v[172:175], v11, s[28:31], s4 offen offset:2048 sc1
L_a_done:
  s_endpgm
.p2align 8
.globl gqa_oproj_kernel
.type gqa_oproj_kernel,@function
gqa_oproj_kernel:
  s_cmp_ge_u32 s2, 256
  s_cbranch_scc1 L_b_done
  s_load_dwordx2 s[40:41], s[0:1], 40
  s_load_dwordx2 s[42:43], s[0:1], 56
  v_and_b32 v1, 63, v0
  v_lshrrev_b32 v2, 6, v0
  s_nop 0
  v_readfirstlane_b32 s3, v2
  s_lshr_b32 s37, s2, 4
  s_and_b32 s38, s2, 15
  s_lshr_b32 s33, s38, 2
  s_and_b32 s4, s38, 3
  s_mul_i32 s4, s4, 6
  s_add_u32 s4, s4, s3
  s_lshr_b32 s34, s4, 3
  s_and_b32 s35, s4, 7
  s_mul_i32 s32, s37, 786432
  s_mul_i32 s4, s33, 12
  s_add_u32 s4, s4, s34
  s_lshl_b32 s4, s4, 10
  s_add_u32 s32, s32, s4
  s_lshl_b32 s4, s35, 7
  s_add_u32 s32, s32, s4
  s_add_u32 s32, s32, 0x2000000
  v_lshrrev_b32 v3, 5, v1
  v_bfe_u32 v4, v1, 4, 1
  v_lshl_add_u32 v5, v4, 1, v3
  v_mul_u32_u24 v5, 3072, v5
  v_and_b32 v11, 15, v1
  v_lshl_add_u32 v11, v11, 3, v5
  s_waitcnt lgkmcnt(0)
  s_mov_b32 s28, s42
  s_and_b32 s29, s43, 0xffff
  s_mov_b32 s30, 0x3000000
  s_mov_b32 s31, 0x20000
  s_add_u32 s5, s32, 0
  buffer_load_dwordx2 v[16:17], v11, s[28:31], s5 offen
  s_add_u32 s5, s32, 49152
  buffer_load_dwordx2 v[18:19], v11, s[28:31], s5 offen
  s_add_u32 s5, s32, 98304
  buffer_load_dwordx2 v[20:21], v11, s[28:31], s5 offen
  s_add_u32 s5, s32, 147456
  buffer_load_dwordx2 v[22:23], v11, s[28:31], s5 offen
  s_add_u32 s5, s32, 196608
  buffer_load_dwordx2 v[24:25], v11, s[28:31], s5 offen
  s_add_u32 s5, s32, 245760
  buffer_load_dwordx2 v[26:27], v11, s[28:31], s5 offen
  s_add_u32 s5, s32, 294912
  buffer_load_dwordx2 v[28:29], v11, s[28:31], s5 offen
  s_add_u32 s5, s32, 344064
  buffer_load_dwordx2 v[30:31], v11, s[28:31], s5 offen
  s_add_u32 s5, s32, 393216
  buffer_load_dwordx2 v[32:33], v11, s[28:31], s5 offen
  s_add_u32 s5, s32, 442368
  buffer_load_dwordx2 v[34:35], v11, s[28:31], s5 offen
  s_add_u32 s5, s32, 491520
  buffer_load_dwordx2 v[36:37], v11, s[28:31], s5 offen
  s_add_u32 s5, s32, 540672
  buffer_load_dwordx2 v[38:39], v11, s[28:31], s5 offen
  s_add_u32 s5, s32, 589824
  buffer_load_dwordx2 v[40:41], v11, s[28:31], s5 offen
  s_add_u32 s5, s32, 638976
  buffer_load_dwordx2 v[42:43], v11, s[28:31], s5 offen
  s_add_u32 s5, s32, 688128
  buffer_load_dwordx2 v[44:45], v11, s[28:31], s5 offen
  s_add_u32 s5, s32, 737280
  buffer_load_dwordx2 v[46:47], v11, s[28:31], s5 offen
  s_mov_b32 s8, s40
  s_and_b32 s9, s41, 0xffff
  s_mov_b32 s10, 786432
  s_mov_b32 s11, 0x20000
  s_mul_i32 s6, s37, 49152
  s_lshl_b32 s5, s33, 8
  s_add_u32 s6, s6, s5
  s_lshl_b32 s5, s34, 14
  s_add_u32 s6, s6, s5
  s_lshr_b32 s5, s35, 1
  s_lshl_b32 s5, s5, 6
  s_add_u32 s6, s6, s5
  s_and_b32 s5, s35, 1
  s_lshl_b32 s5, s5, 13
  s_add_u32 s6, s6, s5
  v_bfe_u32 v2, v1, 1, 3
  v_lshlrev_b32 v2, 10, v2
  v_and_b32 v5, 1, v1
  v_lshl_add_u32 v2, v5, 5, v2
  v_lshl_add_u32 v2, v3, 4, v2
  v_lshl_add_u32 v2, v4, 3, v2
  s_mov_b32 s7, 0xffff0000
  s_waitcnt vmcnt(15)
  v_lshlrev_b32 v4, 16, v16
  v_and_b32 v5, s7, v16
  v_lshlrev_b32 v6, 16, v17
  v_and_b32 v7, s7, v17
  s_waitcnt vmcnt(14)
  v_lshlrev_b32 v12, 16, v18
  v_and_b32 v13, s7, v18
  v_lshlrev_b32 v14, 16, v19
  v_and_b32 v15, s7, v19
  v_pk_add_f32 v[4:5], v[4:5], v[12:13]
  v_pk_add_f32 v[6:7], v[6:7], v[14:15]
  s_waitcnt vmcnt(13)
  v_lshlrev_b32 v8, 16, v20
  v_and_b32 v9, s7, v20
  v_lshlrev_b32 v10, 16, v21
  v_and_b32 v11, s7, v21
  v_pk_add_f32 v[4:5], v[4:5], v[8:9]
  v_pk_add_f32 v[6:7], v[6:7], v[10:11]
  s_waitcnt vmcnt(12)
  v_lshlrev_b32 v12, 16, v22
  v_and_b32 v13, s7, v22
  v_lshlrev_b32 v14, 16, v23
  v_and_b32 v15, s7, v23
  v_pk_add_f32 v[4:5], v[4:5], v[12:13]
  v_pk_add_f32 v[6:7], v[6:7], v[14:15]
  s_waitcnt vmcnt(11)
  v_lshlrev_b32 v8, 16, v24
  v_and_b32 v9, s7, v24
  v_lshlrev_b32 v10, 16, v25
  v_and_b32 v11, s7, v25
  v_pk_add_f32 v[4:5], v[4:5], v[8:9]
  v_pk_add_f32 v[6:7], v[6:7], v[10:11]
  s_waitcnt vmcnt(10)
  v_lshlrev_b32 v12, 16, v26
  v_and_b32 v13, s7, v26
  v_lshlrev_b32 v14, 16, v27
  v_and_b32 v15, s7, v27
  v_pk_add_f32 v[4:5], v[4:5], v[12:13]
  v_pk_add_f32 v[6:7], v[6:7], v[14:15]
  s_waitcnt vmcnt(9)
  v_lshlrev_b32 v8, 16, v28
  v_and_b32 v9, s7, v28
  v_lshlrev_b32 v10, 16, v29
  v_and_b32 v11, s7, v29
  v_pk_add_f32 v[4:5], v[4:5], v[8:9]
  v_pk_add_f32 v[6:7], v[6:7], v[10:11]
  s_waitcnt vmcnt(8)
  v_lshlrev_b32 v12, 16, v30
  v_and_b32 v13, s7, v30
  v_lshlrev_b32 v14, 16, v31
  v_and_b32 v15, s7, v31
  v_pk_add_f32 v[4:5], v[4:5], v[12:13]
  v_pk_add_f32 v[6:7], v[6:7], v[14:15]
  s_waitcnt vmcnt(7)
  v_lshlrev_b32 v8, 16, v32
  v_and_b32 v9, s7, v32
  v_lshlrev_b32 v10, 16, v33
  v_and_b32 v11, s7, v33
  v_pk_add_f32 v[4:5], v[4:5], v[8:9]
  v_pk_add_f32 v[6:7], v[6:7], v[10:11]
  s_waitcnt vmcnt(6)
  v_lshlrev_b32 v12, 16, v34
  v_and_b32 v13, s7, v34
  v_lshlrev_b32 v14, 16, v35
  v_and_b32 v15, s7, v35
  v_pk_add_f32 v[4:5], v[4:5], v[12:13]
  v_pk_add_f32 v[6:7], v[6:7], v[14:15]
  s_waitcnt vmcnt(5)
  v_lshlrev_b32 v8, 16, v36
  v_and_b32 v9, s7, v36
  v_lshlrev_b32 v10, 16, v37
  v_and_b32 v11, s7, v37
  v_pk_add_f32 v[4:5], v[4:5], v[8:9]
  v_pk_add_f32 v[6:7], v[6:7], v[10:11]
  s_waitcnt vmcnt(4)
  v_lshlrev_b32 v12, 16, v38
  v_and_b32 v13, s7, v38
  v_lshlrev_b32 v14, 16, v39
  v_and_b32 v15, s7, v39
  v_pk_add_f32 v[4:5], v[4:5], v[12:13]
  v_pk_add_f32 v[6:7], v[6:7], v[14:15]
  s_waitcnt vmcnt(3)
  v_lshlrev_b32 v8, 16, v40
  v_and_b32 v9, s7, v40
  v_lshlrev_b32 v10, 16, v41
  v_and_b32 v11, s7, v41
  v_pk_add_f32 v[4:5], v[4:5], v[8:9]
  v_pk_add_f32 v[6:7], v[6:7], v[10:11]
  s_waitcnt vmcnt(2)
  v_lshlrev_b32 v12, 16, v42
  v_and_b32 v13, s7, v42
  v_lshlrev_b32 v14, 16, v43
  v_and_b32 v15, s7, v43
  v_pk_add_f32 v[4:5], v[4:5], v[12:13]
  v_pk_add_f32 v[6:7], v[6:7], v[14:15]
  s_waitcnt vmcnt(1)
  v_lshlrev_b32 v8, 16, v44
  v_and_b32 v9, s7, v44
  v_lshlrev_b32 v10, 16, v45
  v_and_b32 v11, s7, v45
  v_pk_add_f32 v[4:5], v[4:5], v[8:9]
  v_pk_add_f32 v[6:7], v[6:7], v[10:11]
  s_waitcnt vmcnt(0)
  v_lshlrev_b32 v12, 16, v46
  v_and_b32 v13, s7, v46
  v_lshlrev_b32 v14, 16, v47
  v_and_b32 v15, s7, v47
  v_pk_add_f32 v[4:5], v[4:5], v[12:13]
  v_pk_add_f32 v[6:7], v[6:7], v[14:15]
  v_cvt_pk_bf16_f32 v4, v4, v5
  v_cvt_pk_bf16_f32 v5, v6, v7
  s_nop 1
  v_permlane32_swap_b32 v4, v5
  s_nop 1
  buffer_store_dwordx2 v[4:5], v2, s[8:11], s6 offen
L_b_done:
  s_endpgm
L_text_end:
.section .rodata,"a"
.p2align 6
.amdhsa_kernel gqa_attn_kernel
  .amdhsa_next_free_vgpr 512
  .amdhsa_next_free_sgpr 96
  .amdhsa_accum_offset 256
  .amdhsa_group_segment_fixed_size 0
  .amdhsa_kernarg_size 64
  .amdhsa_user_sgpr_count 2
  .amdhsa_user_sgpr_kernarg_segment_ptr 1
  .amdhsa_system_sgpr_workgroup_id_x 1
.end_amdhsa_kernel
.p2align 6
.amdhsa_kernel gqa_oproj_kernel
  .amdhsa_next_free_vgpr 48
  .amdhsa_next_free_sgpr 72
  .amdhsa_accum_offset 48
  .amdhsa_group_segment_fixed_size 0
  .amdhsa_kernarg_size 64
  .amdhsa_user_sgpr_count 2
  .amdhsa_user_sgpr_kernarg_segment_ptr 1
  .amdhsa_system_sgpr_workgroup_id_x 1
.end_amdhsa_kernel
```
